```python
import torch

def _softmax(x, axis=-1):
    return torch.softmax(x, dim=axis)
def _gelu(x):
    return torch.nn.functional.gelu(x, approximate="tanh")
def _silu(x):
    return torch.nn.functional.silu(x)
def _sigmoid(x):
    return torch.sigmoid(x)
def _layernorm(x, axis=-1, eps=1e-5):
    m = x.mean(dim=axis, keepdim=True)
    v = x.var(dim=axis, keepdim=True, unbiased=False)
    return (x - m) / torch.sqrt(v + eps)
def _scatter_add(tgt, idx, src, axis=0):
    return tgt.clone().index_add_(axis, idx, src)
def _segment_sum(src, seg, n):
    out = torch.zeros((n,) + src.shape[1:], dtype=src.dtype)
    return out.index_add_(0, seg, src)
def _pad(x, pw):
    flat = tuple(v for pair in reversed(pw) for v in pair)
    return torch.nn.functional.pad(x, flat)

kernel_name = 'sequential_preLN__ssm_conv_s4d__swiglu_ffn__prompt'

def setup_inputs():

    _w = (lambda a: (lambda t: t.to(torch.bfloat16) if t.is_floating_point() else t)(torch.as_tensor(a)))
    def _A_setup():
        Bsz, L, D, N = 1, 2048, 512, 128
        return {
            "u": _w((lambda *s: torch.randn(*s, dtype=torch.bfloat16) * 0.05)(Bsz, L, D)),
            "log_A_real": _w((lambda *s: torch.randn(*s, dtype=torch.bfloat16) * 6.4)(D, N) * 0.5),
            "A_imag": _w((lambda *s: torch.randn(*s, dtype=torch.bfloat16) * 0.05)(D, N) * 3.14),
            "C_real": _w((lambda *s: torch.randn(*s, dtype=torch.bfloat16) * 0.05)(D, N) / N ** 0.5),
            "C_imag": _w((lambda *s: torch.randn(*s, dtype=torch.bfloat16) * 0.05)(D, N) / N ** 0.5),
            "log_dt": _w((lambda *s: torch.randn(*s, dtype=torch.bfloat16) * 0.05)(D) * 0.5 - 4.0),
            "D_skip": _w((lambda *s: torch.randn(*s, dtype=torch.bfloat16) * 0.05)(D)),
        }
    _A_in = _A_setup()

    def _B_setup():
        B, S, D, F = 1, 2048, 512, 1792
        return {
            "x": _w((lambda *s: torch.randn(*s, dtype=torch.bfloat16) * 0.05)(B, S, D)),
            "w_gate": _w((lambda *s: torch.randn(*s, dtype=torch.bfloat16) * 0.05)(D, F)),
            "w_up": _w((lambda *s: torch.randn(*s, dtype=torch.bfloat16) * 0.05)(D, F)),
            "w_down": _w((lambda *s: torch.randn(*s, dtype=torch.bfloat16) * 0.05)(F, D)),
        }
    _B_in = _B_setup()

    return {
        "A_u": _A_in["u"],
        "A_log_A_real": _A_in["log_A_real"],
        "A_A_imag": _A_in["A_imag"],
        "A_C_real": _A_in["C_real"],
        "A_C_imag": _A_in["C_imag"],
        "A_log_dt": _A_in["log_dt"],
        "A_D_skip": _A_in["D_skip"],
        "B_x": _B_in["x"],
        "B_w_gate": _B_in["w_gate"],
        "B_w_up": _B_in["w_up"],
        "B_w_down": _B_in["w_down"],
    }

def reference(A_u, A_log_A_real, A_A_imag, A_C_real, A_C_imag, A_log_dt, A_D_skip, B_x, B_w_gate, B_w_up, B_w_down):
    def _A_ref(u, log_A_real, A_imag, C_real, C_imag, log_dt, D_skip):
        L = u.shape[1]
        dt = torch.exp(log_dt)
        A = -torch.exp(log_A_real) + 1j * A_imag
        C = (C_real + 1j * C_imag) * dt[:, None]
        pos = (lambda x, dt: x.to(dt))(torch.arange(L), log_dt.dtype)
        P = torch.exp((A * dt[:, None])[:, :, None] * pos[None, None, :])
        K = 2.0 * torch.einsum("dn,dnl->dl", C, P).real
        L2 = 2 * L
        u_t = (lambda x, *d: x.permute(*d))(u, 0, 2, 1)
        Kf = (lambda x, *a, **k: torch.fft.rfft(x.float(), *a, **k))(K, L2)
        Uf = (lambda x, *a, **k: torch.fft.rfft(x.float(), *a, **k))(u_t, L2)
        y = (lambda x, *a, **k: torch.fft.irfft(x, *a, **k).to(torch.bfloat16))(Uf * Kf[None, :, :], L2)[:, :, :L]
        y = (lambda x, *d: x.permute(*d))(y, 0, 2, 1)
        return y + u * D_skip[None, None, :]

    def _B_ref(x, w_gate, w_up, w_down):
        g = _silu(x @ w_gate)
        u = x @ w_up
        return (g * u) @ w_down

    x = A_u
    h = x + _A_ref(_layernorm(x, axis=-1), A_log_A_real, A_A_imag, A_C_real, A_C_imag, A_log_dt, A_D_skip)
    h2 = h + _B_ref(_layernorm(h, axis=-1), B_w_gate, B_w_up, B_w_down)
    return h2
```

```asm
; @launch grid=(256,1,1) block=(512,1,1) lds=163840
.amdgcn_target "amdgcn-amd-amdhsa--gfx950"
.text
.globl sequential_preLN__ssm_conv_s4d__swiglu_ffn__prompt_kernel
.p2align 8
.type sequential_preLN__ssm_conv_s4d__swiglu_ffn__prompt_kernel,@function
sequential_preLN__ssm_conv_s4d__swiglu_ffn__prompt_kernel:
    s_load_dwordx16 s[16:31], s[0:1], 0
    s_load_dwordx8 s[32:39], s[0:1], 64
    s_load_dwordx4 s[40:43], s[0:1], 96
    v_lshrrev_b32 v2, 6, v0
    s_cmp_ge_u32 s2, 256
    s_cbranch_scc1 L_end
    v_readfirstlane_b32 s3, v2
    s_getpc_b64 s[14:15]
L_pc0:
    s_sub_u32 s14, s14, L_pc0-sequential_preLN__ssm_conv_s4d__swiglu_ffn__prompt_kernel
    s_subb_u32 s15, s15, 0
    v_min_u32 v3, 15, v0
    s_lshr_b32 s11, s2, 3
    s_lshl_b32 s11, s11, 11
    v_lshl_add_u32 v3, v3, 7, s11
    v_min_u32 v3, L_code_end-sequential_preLN__ssm_conv_s4d__swiglu_ffn__prompt_kernel-4, v3
    global_load_dword v255, v3, s[14:15]
    s_lshl_b32 s11, s3, 2
    s_lshr_b32 s11, 0xdddd4321, s11
    s_and_b32 s11, s11, 15
    s_lshl_b32 s11, s11, 3
    s_load_dwordx2 s[74:75], s[0:1], s11
    v_and_b32 v1, 63, v0
    s_lshr_b32 s11, s2, 2
    s_lshl_b32 s11, s11, 5
    s_and_b32 s12, s2, 3
    s_add_u32 s11, s11, s12
    s_lshl_b32 s11, s11, 10
    v_lshl_add_u32 v4, v1, 4, s11
    v_lshl_add_u32 v4, v2, 12, v4
    s_and_b32 s11, s2, 7
    s_lshr_b32 s12, s2, 3
    s_lshl_b32 s4, s11, 5
    s_add_u32 s4, s4, s12
    s_lshr_b32 s5, s11, 2
    s_lshl_b32 s5, s5, 3
    s_lshr_b32 s13, s12, 2
    s_add_u32 s5, s5, s13
    s_and_b32 s6, s11, 3
    s_lshl_b32 s6, s6, 2
    s_and_b32 s13, s12, 3
    s_add_u32 s6, s6, s13
    v_lshlrev_b32 v251, 8, v1
    v_mov_b32 v252, 0
    v_mov_b32 v253, 1
    s_mul_i32 s79, s2, 16640
    s_lshl_b32 s11, s4, 9
    s_cmp_lt_u32 s3, 4
    s_cselect_b32 s11, s11, s79
    s_cselect_b32 s12, 16, 0
    s_cmp_eq_u32 s3, 5
    s_cselect_b32 s11, 15663104, s11
    v_mul_u32_u24 v6, s12, v1
    v_add_u32 v6, s11, v6
    s_lshl_b32 s11, s3, 9
    s_add_u32 m0, s11, 78848
    s_xor_b32 s13, s3, 4
    s_lshr_b32 s11, s2, 4
    s_or_b32 s59, s11, s13
    s_lshl_b32 s11, s2, 8
    s_add_u32 s11, s11, 15597568
    v_lshl_add_u32 v2, v1, 12, s11
    s_cmp_lg_u32 s59, 0
    s_waitcnt lgkmcnt(0)
    s_cbranch_scc1 L_zero_skip
    s_mov_b64 exec, 0x1fff
    global_store_dword v2, v252, s[42:43] sc1
    global_load_dword v254, v252, s[40:41] offset:128 sc1
    s_mov_b64 exec, -1
L_zero_skip:
    global_load_dwordx4 v[8:11], v4, s[16:17]
    s_mov_b32 exec_hi, 0
    global_load_lds_dwordx4 v6, s[74:75] sc1
    s_mov_b32 exec_hi, -1
    s_and_b32 s11, s2, 7
    s_lshr_b32 s12, s2, 3
    s_lshr_b32 s7, s11, 1
    s_lshl_b32 s7, s7, 3
    s_lshr_b32 s13, s12, 2
    s_add_u32 s7, s7, s13
    s_and_b32 s8, s11, 1
    s_lshl_b32 s8, s8, 2
    s_and_b32 s13, s12, 3
    s_add_u32 s8, s8, s13
    s_lshl_b32 s13, s4, 2
    s_load_dword s72, s[26:27], s13
    s_load_dword s73, s[28:29], s13
    s_mov_b32 s44, s42
    s_mov_b32 s45, s43
    s_mov_b32 s46, 18874368
    s_mov_b32 s47, 0x20000
    s_lshr_b32 s9, s3, 2
    s_and_b32 s10, s3, 3
    s_mov_b32 s76, 0x3f803f80
    s_mul_i32 s11, s3, 2112
    s_add_u32 s11, s11, 61440
    v_lshl_add_u32 v44, v1, 5, s11
    v_bfe_u32 v40, v1, 2, 2
    v_lshrrev_b32 v41, 4, v1
    v_and_b32 v42, 3, v1
    v_and_b32 v43, 15, v1
    v_mul_u32_u24 v45, 2112, v40
    v_lshl_add_u32 v45, v41, 5, v45
    v_lshl_add_u32 v45, v42, 3, v45
    s_lshl_b32 s11, s3, 8
    s_add_u32 s11, s11, 61440
    v_add_u32 v45, s11, v45
    v_lshlrev_b32 v46, 4, v1
    s_mul_i32 s23, s2, 16640
    s_lshl_b32 s11, s3, 11
    s_add_u32 s23, s23, s11
    s_and_b32 s11, s2, 15
    s_lshl_b32 s11, s11, 8
    s_lshl_b32 s12, s3, 12
    s_add_u32 s11, s11, s12
    s_add_u32 s77, s11, 15597568
    s_and_b32 s11, s2, 7
    s_lshl_b32 s11, s11, 12
    s_add_u32 s78, s11, 15597568
    s_cmp_lt_u32 s3, 4
    s_cselect_b32 s48, s32, s34
    s_cselect_b32 s49, s33, s35
    s_mov_b32 s50, 1835008
    s_mov_b32 s51, 0x20000
    v_lshrrev_b32 v7, 3, v1
    v_mul_u32_u24 v7, 3584, v7
    v_and_b32 v3, 7, v1
    v_lshl_add_u32 v7, v3, 4, v7
    s_lshl_b32 s11, s5, 2
    s_add_u32 s11, s11, s10
    s_mul_i32 s11, s11, 28672
    s_lshl_b32 s12, s6, 7
    s_add_u32 s21, s11, s12
    s_lshl_b32 s12, s3, 10
    s_add_u32 s22, s12, 83968
    s_mov_b32 s52, s36
    s_mov_b32 s53, s37
    s_mov_b32 s54, 1835008
    s_mov_b32 s55, 0x20000
    v_mov_b32 v28, 0
    v_mov_b32 v29, 0
    s_lshr_b32 s11, s3, 1
    s_mul_i32 s11, s11, 5136
    s_add_u32 s11, s11, 106624
    v_and_b32 v3, 127, v0
    v_lshl_add_u32 v2, v3, 3, s11
    ds_write_b64 v2, v[28:29]
    v_lshlrev_b32 v2, 2, v43
    v_add_u32 v2, 98304, v2
    ds_write_b32 v2, v28
    ds_write_b32 v2, v28 offset:4160
    v_mov_b32 v2, 136704
    ds_write_b32 v2, v28
    ds_write_b32 v2, v28 offset:2320
    ds_write_b32 v2, v28 offset:4736
    ds_write_b32 v2, v28 offset:16640
    ds_write_b32 v2, v28 offset:18960
    ds_write_b32 v2, v28 offset:21376
    s_lshl_b32 s11, s10, 7
    s_add_u32 s11, s11, 78848
    v_lshl_add_u32 v5, v1, 1, s11
    s_and_b32 s11, s11, 0xffffff00
    v_lshl_add_u32 v6, v1, 2, s11
    s_and_b32 s11, s3, 2
    s_mul_i32 s11, s11, 15048
    s_and_b32 s12, s3, 1
    s_lshl_b32 s12, s12, 8
    s_add_u32 s11, s11, s12
    v_lshl_add_u32 v79, v1, 2, s11
    s_and_b32 s11, s3, 1
    s_mul_i32 s12, s11, 30096
    v_mul_u32_u24 v32, 528, v43
    v_and_b32 v2, 1, v41
    v_lshl_add_u32 v32, v2, 8, v32
    v_lshrrev_b32 v2, 1, v41
    v_lshl_add_u32 v32, v2, 7, v32
    v_add_u32 v32, s12, v32
    s_lshr_b32 s12, s3, 1
    s_lshl_b32 s11, s11, 11
    s_lshl_b32 s79, s12, 9
    s_add_u32 s11, s11, s79
    v_lshl_add_u32 v34, v1, 3, s11
    s_mul_i32 s12, s12, 8448
    v_add_u32 v33, s12, v32
    s_cmp_lt_u32 s10, 2
    s_cselect_b32 s11, 2, 1
    s_cselect_b32 s12, 3, 1
    v_lshrrev_b32 v28, s11, v1
    v_mul_u32_u24 v28, 3584, v28
    v_and_b32 v2, s12, v1
    v_lshl_add_u32 v28, v2, 4, v28
    s_add_u32 s11, s11, 4
    s_lshl_b32 s26, s6, s11
    s_mul_i32 s12, s5, 114688
    s_add_u32 s26, s26, s12
    s_mul_i32 s12, s10, 57344
    s_add_u32 s12, s12, 2048
    s_lshl_b32 s13, s9, 1
    s_add_u32 s13, s13, s10
    s_add_u32 s27, s9, 4
    s_cmp_lt_u32 s10, 2
    s_cselect_b32 s12, s12, 3072
    s_cselect_b32 s27, s13, s27
    s_add_u32 s26, s26, s12
    s_lshl_b32 s27, s27, 10
    s_add_u32 s27, s27, 92160
    s_cmp_eq_u32 s10, 3
    s_cselect_b32 s26, 0x7fff0000, s26
    s_cselect_b32 s27, 80896, s27
    v_lshlrev_b32 v35, 4, v0
    v_add_u32 v35, L_gtab-sequential_preLN__ssm_conv_s4d__swiglu_ffn__prompt_kernel, v35
    s_lshl_b32 s25, s2, 8
    s_add_u32 s25, s25, 15728640
    v_lshlrev_b32 v47, 2, v1
    s_cmp_eq_u32 s3, 0
    s_cselect_b64 s[82:83], -1, 0
    v_and_b32 v2, 255, v0
    s_mul_i32 s11, s9, 4160
    s_add_u32 s11, s11, 98368
    v_lshl_add_u32 v31, v2, 4, s11
    s_and_b32 s11, s3, 2
    s_lshl_b32 s11, s11, 1
    s_add_u32 s11, s11, 162928
    v_mov_b32 v30, s11
    v_mov_b32 v48, 0
    v_mov_b32 v49, 0
    s_mov_b32 s64, s32
    s_mov_b32 s65, s33
    s_mov_b32 s66, 1835008
    s_mov_b32 s67, 0x20000
    s_mov_b32 s68, s34
    s_mov_b32 s69, s35
    s_mov_b32 s70, 1835008
    s_mov_b32 s71, 0x20000
    s_mov_b32 s56, s38
    s_mov_b32 s57, s39
    s_mov_b32 s58, 2097152
    s_mov_b32 s59, 0x20000
    s_mov_b32 s80, 0x00003f80
    s_mov_b32 s81, 0x3f800000
    v_lshrrev_b32 v15, 3, v1
    s_lshl_b32 s11, s3, 3
    v_add_u32 v16, s11, v15
    v_and_b32 v17, 1, v40
    v_lshrrev_b32 v18, 2, v16
    v_and_b32 v19, 3, v18
    v_xor_b32 v19, v19, v17
    v_mul_u32_u24 v2, 5136, v42
    v_lshl_add_u32 v2, v16, 6, v2
    v_add_u32 v2, 107648, v2
    v_lshl_add_u32 v225, v19, 4, v2
    v_xor_b32 v19, 2, v19
    v_lshl_add_u32 v226, v19, 4, v2
    v_mul_u32_u24 v2, 148, v42
    v_and_b32 v3, 1, v42
    v_mul_u32_u24 v3, 3, v3
    v_sub_u32 v2, v2, v3
    v_lshl_add_u32 v2, v16, 1, v2
    v_add_u32 v2, v2, v18
    v_mul_u32_u24 v3, 16640, v17
    v_lshl_add_u32 v227, v2, 4, v3
    v_add_u32 v227, 127232, v227
    v_add_u32 v228, 9472, v227
    v_mov_b32 v2, 106624
    v_cmp_eq_u32 vcc, 3, v42
    v_mul_u32_u24 v229, 34688, v15
    v_add_u32 v229, v229, v46
    v_cndmask_b32 v228, v228, v2, vcc
    s_mul_i32 s20, s3, 278528
    s_lshl_b32 s11, s4, 7
    s_add_u32 s20, s20, s11
    s_add_u32 s20, s20, 4718592
    v_lshlrev_b32 v2, 2, v17
    v_add_u32 v230, 162928, v2
    v_lshlrev_b32 v231, 4, v17
    s_lshr_b32 s11, s10, 1
    s_lshl_b32 s11, s11, 13
    s_and_b32 s12, s10, 1
    s_lshl_b32 s12, s12, 11
    s_add_u32 s24, s11, s12
    s_cmp_ge_u32 s3, 4
    s_cbranch_scc1 L_cs_help
    s_and_b32 s11, s3, 1
    s_mul_i32 s12, s11, 4160
    s_add_u32 s12, s12, 98528
    v_lshl_add_u32 v2, v41, 3, v40
    v_sub_u32 v2, v42, v2
    v_lshl_add_u32 v232, v2, 3, s12
    s_and_b32 s11, s3, 1
    v_add3_u32 v2, v43, v41, 1
    v_lshlrev_b32 v3, 6, v2
    v_lshrrev_b32 v2, 2, v2
    v_add_u32 v15, 3, v2
    v_and_b32 v15, 3, v15
    v_xor_b32 v15, s11, v15
    v_lshl_add_u32 v15, v15, 4, v3
    v_add_u32 v235, 107392, v15
    v_add_u32 v15, 2, v2
    v_and_b32 v15, 3, v15
    v_xor_b32 v15, s11, v15
    v_lshl_add_u32 v15, v15, 4, v3
    v_add_u32 v236, 107136, v15
    v_add_u32 v15, 1, v2
    v_and_b32 v15, 3, v15
    v_xor_b32 v15, s11, v15
    v_lshl_add_u32 v15, v15, 4, v3
    v_add_u32 v237, 106880, v15
    v_add_u32 v15, 0, v2
    v_and_b32 v15, 3, v15
    v_xor_b32 v15, s11, v15
    v_lshl_add_u32 v15, v15, 4, v3
    v_add_u32 v238, 106624, v15
    s_mul_i32 s12, s11, 16640
    s_add_u32 s12, s12, 127232
    v_lshl_add_u32 v2, v43, 1, v40
    v_lshl_add_u32 v2, v2, 2, v41
    v_lshl_add_u32 v233, v2, 2, s12
    v_and_b32 v2, 51, v1
    v_cmp_eq_u32 vcc, 51, v2
    v_mov_b32 v2, 20
    s_nop 0
    v_cndmask_b32 v2, v2, 36, vcc
    v_add_u32 v234, v233, v2
    s_branch L_cs_done
L_cs_help:
    v_xor_b32 v2, v42, v41
    v_lshlrev_b32 v2, 4, v2
    v_lshrrev_b32 v3, 2, v1
    v_mul_u32_u24 v234, 66560, v3
    v_add_u32 v234, v234, v2
    s_mul_i32 s18, s10, 16640
    s_lshl_b32 s13, s4, 6
    s_add_u32 s18, s18, s13
    s_mul_i32 s19, s10, 5136
    s_add_u32 s19, s19, 107648
    v_bfe_u32 v3, v1, 1, 2
    v_and_b32 v18, 1, v41
    v_xor_b32 v3, v3, v18
    v_mul_u32_u24 v232, 3584, v15
    v_and_b32 v19, 1, v1
    v_lshl_add_u32 v232, v19, 4, v232
    v_lshl_add_u32 v232, v3, 5, v232
    v_xor_b32 v233, 64, v232
    v_lshrrev_b32 v3, 1, v41
    v_lshl_add_u32 v19, v3, 3, v40
    v_lshlrev_b32 v2, 3, v42
    v_lshl_add_u32 v236, v18, 12, v2
    v_lshl_add_u32 v236, v19, 7, v236
    s_lshl_b32 s11, s10, 5
    s_add_u32 s11, s11, 83968
    v_add_u32 v236, s11, v236
    s_cmp_lt_u32 s10, 2
    s_cselect_b32 s12, 6, 5
    s_cselect_b32 s13, s11, 88064
    s_add_u32 s13, s13, 8192
    v_lshl_add_u32 v237, v18, 5, v19
    v_lshlrev_b32 v237, s12, v237
    v_add3_u32 v237, v237, v2, s13
    s_lshl_b32 s13, 4, s12
    v_add_u32 v238, s13, v237
    s_lshl_b32 s13, 16, s12
    v_add_u32 v239, s13, v237
    v_add_u32 v240, s13, v238
    v_and_b32 v2, 31, v1
    v_lshlrev_b32 v2, 1, v2
    v_lshl_add_u32 v235, v3, 8, v2
L_cs_done:
    s_xor_b32 s13, s3, 4
    s_lshr_b32 s11, s2, 4
    s_or_b32 s13, s11, s13
    s_cbranch_scc1 L_zero_back
    v_mov_b32 v29, s2
    s_mov_b64 exec, 1
    s_waitcnt vmcnt(2)
    global_store_byte v29, v253, s[40:41] sc1
    s_mov_b64 exec, -1
L_zero_back:
    s_waitcnt vmcnt(1)
    v_dot2c_f32_bf16 v48, s76, v8
    v_dot2c_f32_bf16 v49, v8, v8
    v_dot2c_f32_bf16 v48, s76, v9
    v_dot2c_f32_bf16 v49, v9, v9
    v_dot2c_f32_bf16 v48, s76, v10
    v_dot2c_f32_bf16 v49, v10, v10
    v_dot2c_f32_bf16 v48, s76, v11
    v_dot2c_f32_bf16 v49, v11, v11
    v_lshlrev_b32 v56, 16, v8
    v_and_b32 v57, 0xffff0000, v8
    v_lshlrev_b32 v58, 16, v9
    v_and_b32 v59, 0xffff0000, v9
    v_lshlrev_b32 v60, 16, v10
    v_and_b32 v61, 0xffff0000, v10
    v_lshlrev_b32 v62, 16, v11
    v_and_b32 v63, 0xffff0000, v11
    v_add_f32_dpp v48, v48, v48 quad_perm:[1,0,3,2] row_mask:0xf bank_mask:0xf
    v_add_f32_dpp v49, v49, v49 quad_perm:[1,0,3,2] row_mask:0xf bank_mask:0xf
    v_mov_b32 v71, v11
    v_add_f32_dpp v48, v48, v48 quad_perm:[2,3,0,1] row_mask:0xf bank_mask:0xf
    v_add_f32_dpp v49, v49, v49 quad_perm:[2,3,0,1] row_mask:0xf bank_mask:0xf
    v_mov_b32 v69, v10
    v_add_f32_dpp v48, v48, v48 row_half_mirror row_mask:0xf bank_mask:0xf
    v_add_f32_dpp v49, v49, v49 row_half_mirror row_mask:0xf bank_mask:0xf
    v_mov_b32 v67, v9
    v_add_f32_dpp v48, v48, v48 row_mirror row_mask:0xf bank_mask:0xf
    v_add_f32_dpp v49, v49, v49 row_mirror row_mask:0xf bank_mask:0xf
    v_mov_b32 v65, v8
    v_add_f32_dpp v48, v48, v48 row_bcast:15 row_mask:0xa bank_mask:0xf
    v_add_f32_dpp v49, v49, v49 row_bcast:15 row_mask:0xa bank_mask:0xf
    s_nop 0
    v_add_f32_dpp v48, v48, v48 row_bcast:31 row_mask:0xc bank_mask:0xf
    v_add_f32_dpp v49, v49, v49 row_bcast:31 row_mask:0xc bank_mask:0xf
    v_readlane_b32 s11, v48, 63
    v_readlane_b32 s12, v49, 63
    s_nop 0
    v_mov_b32 v48, s11
    v_mov_b32 v49, s12
    v_mul_f32 v50, 0x3b000000, v48
    v_mul_f32 v52, v50, v50
    v_mul_f32 v51, 0x3b000000, v49
    v_sub_f32 v51, v51, v52
    v_max_f32 v51, 0, v51
    v_cvt_pk_bf16_f32 v52, v50, v51
    v_lshlrev_b32 v50, 16, v52
    v_and_b32 v51, 0xffff0000, v52
    v_add_f32 v51, 0x3727c5ac, v51
    v_cvt_pk_bf16_f32 v52, v51, v51
    v_lshlrev_b32 v51, 16, v52
    v_sqrt_f32 v51, v51
    s_nop 0
    v_cvt_pk_bf16_f32 v52, v51, v51
    v_lshlrev_b32 v51, 16, v52
    v_rcp_f32 v51, v51
    v_sub_f32 v56, v56, v50
    v_sub_f32 v57, v57, v50
    v_sub_f32 v58, v58, v50
    v_sub_f32 v59, v59, v50
    v_sub_f32 v60, v60, v50
    v_sub_f32 v61, v61, v50
    v_sub_f32 v62, v62, v50
    v_sub_f32 v63, v63, v50
    v_cvt_pk_bf16_f32 v52, v56, v57
    v_cvt_pk_bf16_f32 v53, v58, v59
    v_cvt_pk_bf16_f32 v54, v60, v61
    v_cvt_pk_bf16_f32 v55, v62, v63
    v_lshlrev_b32 v56, 16, v52
    v_and_b32 v57, 0xffff0000, v52
    v_lshlrev_b32 v58, 16, v53
    v_and_b32 v59, 0xffff0000, v53
    v_lshlrev_b32 v60, 16, v54
    v_and_b32 v61, 0xffff0000, v54
    v_lshlrev_b32 v62, 16, v55
    v_and_b32 v63, 0xffff0000, v55
    v_mul_f32 v56, v56, v51
    v_mul_f32 v57, v57, v51
    v_mul_f32 v58, v58, v51
    v_mul_f32 v59, v59, v51
    v_mul_f32 v60, v60, v51
    v_mul_f32 v61, v61, v51
    v_mul_f32 v62, v62, v51
    v_mul_f32 v63, v63, v51
    v_cvt_pk_bf16_f32 v52, v56, v57
    v_cvt_pk_bf16_f32 v53, v58, v59
    v_cvt_pk_bf16_f32 v54, v60, v61
    v_cvt_pk_bf16_f32 v55, v62, v63
    v_lshlrev_b32 v56, 16, v52
    v_and_b32 v57, 0xffff0000, v52
    v_lshlrev_b32 v58, 16, v53
    v_and_b32 v59, 0xffff0000, v53
    v_lshlrev_b32 v60, 16, v54
    v_and_b32 v61, 0xffff0000, v54
    v_lshlrev_b32 v62, 16, v55
    v_and_b32 v63, 0xffff0000, v55
    v_cvt_pk_f16_f32 v64, v56, v57
    v_cvt_pk_f16_f32 v66, v58, v59
    v_cvt_pk_f16_f32 v68, v60, v61
    v_cvt_pk_f16_f32 v70, v62, v63
    ds_write_b128 v44, v[64:67]
    ds_write_b128 v44, v[68:71] offset:16
    s_cmp_ge_u32 s3, 4
    s_cbranch_scc1 L_noauxw
    s_waitcnt vmcnt(0)
L_noauxw:
    s_waitcnt lgkmcnt(0)
    s_barrier
    ds_read_b64_tr_b16 v[56:57], v45
    ds_read_b64_tr_b16 v[58:59], v45 offset:8448
    ds_read_b64_tr_b16 v[60:61], v45 offset:128
    ds_read_b64_tr_b16 v[62:63], v45 offset:8576
    ds_read_b32 v16, v6 offset:1024
    ds_read_b32 v17, v6 offset:1536
    ds_read_u16_d16_hi v12, v5
    ds_read_u16_d16_hi v13, v5 offset:512
    ds_read_u16_d16_hi v14, v5 offset:1024
    ds_read_u16_d16_hi v15, v5 offset:1536
    s_waitcnt lgkmcnt(8)
    buffer_store_dwordx4 v[56:59], v46, s[44:47], s23 offen sc1
    s_waitcnt lgkmcnt(6)
    buffer_store_dwordx4 v[60:63], v46, s[44:47], s23 offen offset:1024 sc1
    s_mov_b64 exec, s[82:83]
    buffer_store_dword v252, v47, s[44:47], s25 offen sc1
    s_mov_b64 exec, -1
    global_load_dwordx4 v[36:39], v35, s[14:15]
    s_lshl_b32 s12, s72, 16
    s_and_b32 s13, s72, 0xffff0000
    s_bitcmp1_b32 s3, 1
    s_cselect_b32 s12, s13, s12
    v_mov_b32 v18, s12
    v_mul_f32 v72, 0x3fb8aa00, v18
    v_mul_f32 v73, 0x36eca570, v18
    s_waitcnt lgkmcnt(4)
    v_and_b32 v16, 0x7fff7fff, v16
    v_and_b32 v17, 0x7fff7fff, v17
    v_pk_max_u16 v16, v16, v17
    v_exp_f32 v72, v72
    v_lshrrev_b32 v17, 16, v16
    v_and_b32 v16, 0xffff, v16
    v_max_u32 v16, v16, v17
    s_waitcnt lgkmcnt(0)
    v_exp_f32 v73, v73
    v_mul_f32 v74, 0x3fb8aa00, v12
    v_max_u32_dpp v16, v16, v16 quad_perm:[1,0,3,2] row_mask:0xf bank_mask:0xf
    v_mul_f32 v75, 0x36eca570, v12
    v_exp_f32 v74, v74
    v_max_u32_dpp v16, v16, v16 quad_perm:[2,3,0,1] row_mask:0xf bank_mask:0xf
    v_exp_f32 v75, v75
    v_mul_f32 v72, v72, v73
    v_max_u32_dpp v16, v16, v16 row_half_mirror row_mask:0xf bank_mask:0xf
    v_mov_b32 v17, 0x3e22f983
    v_mul_f32 v74, v74, v75
    v_max_u32_dpp v16, v16, v16 row_mirror row_mask:0xf bank_mask:0xf
    v_cvt_pk_bf16_f32 v72, v72, v74
    v_and_b32 v74, 0xffff0000, v72
    v_max_u32_dpp v16, v16, v16 row_bcast:15 row_mask:0xa bank_mask:0xf
    v_lshlrev_b32 v72, 16, v72
    v_mul_f32 v74, v74, v72
    v_max_u32_dpp v16, v16, v16 row_bcast:31 row_mask:0xc bank_mask:0xf
    v_mul_f32 v13, v13, v72
    v_readlane_b32 s11, v16, 63
    v_mul_f32 v74, 0xbfb8aa3b, v74
    v_mul_f32 v75, 0x3e22f983, v13
    v_fma_f32 v78, v13, v17, -v75
    v_fmac_f32 v78, 0x31dc9c88, v13
    s_lshr_b32 s11, s11, 7
    s_max_u32 s11, s11, 8
    s_sub_u32 s12, 261, s11
    s_lshl_b32 s12, s12, 23
    s_sub_u32 s13, s11, 6
    s_lshl_b32 s13, s13, 23
    v_mul_f32 v73, s13, v72
    v_mul_f32 v76, s12, v14
    v_mul_f32 v77, s12, v15
    ds_write_b32 v30, v73
    s_mov_b32 m0, s22
    s_nop 0
    buffer_load_dwordx4 v7, s[48:51], s21 offen lds
    v_mul_f32 v80, 0x43000000, v75
    v_mul_f32 v81, 0x43000000, v74
    v_fract_f32 v80, v80
    v_exp_f32 v81, v81
    v_fmac_f32 v80, 0x43000000, v78
    v_cos_f32 v90, v80
    v_sin_f32 v91, v80
    v_mul_f32 v90, v90, v81
    v_mul_f32 v91, v91, v81
    s_cmp_lg_u32 s9, 0
    s_cbranch_scc1 L_set1_1
    v_mul_f32 v80, 0x41000000, v75
    v_mul_f32 v81, 0x41000000, v74
    v_fract_f32 v80, v80
    v_exp_f32 v81, v81
    v_fmac_f32 v80, 0x41000000, v78
    v_cos_f32 v86, v80
    v_sin_f32 v87, v80
    v_mul_f32 v86, v86, v81
    v_mul_f32 v87, v87, -v81
    v_fract_f32 v80, v75
    v_exp_f32 v81, v74
    v_add_f32 v80, v78, v80
    v_cos_f32 v88, v80
    v_sin_f32 v89, v80
    v_mul_f32 v88, v88, v81
    v_mul_f32 v89, v89, v81
    v_mov_b32 v82, 0x3c00
    ds_write_b32 v79, v82 offset:21648
    v_cvt_pk_f16_f32 v82, v86, v87
    ds_write_b32 v79, v82 offset:22176
    v_cvt_pk_f16_f32 v83, v76, v77
    ds_write_b32 v79, v83 offset:0
    v_pk_mul_f32 v[92:93], v[76:77], v[90:91] op_sel:[0,0] op_sel_hi:[1,0]
    v_pk_fma_f32 v[92:93], v[76:77], v[90:91], v[92:93] op_sel:[1,1,0] op_sel_hi:[0,1,1] neg_lo:[1,0,0]
    v_cvt_pk_f16_f32 v84, v92, v93
    ds_write_b32 v79, v84 offset:4224
    v_pk_mul_f32 v[106:107], v[86:87], v[86:87] op_sel:[0,0] op_sel_hi:[1,0]
    v_pk_fma_f32 v[106:107], v[86:87], v[86:87], v[106:107] op_sel:[1,1,0] op_sel_hi:[0,1,1] neg_lo:[1,0,0]
    v_cvt_pk_f16_f32 v85, v106, v107
    ds_write_b32 v79, v85 offset:22704
    s_load_dwordx4 s[28:31], s[40:41], 0
    v_pk_mul_f32 v[94:95], v[86:87], v[106:107] op_sel:[0,0] op_sel_hi:[1,0]
    v_pk_fma_f32 v[94:95], v[86:87], v[106:107], v[94:95] op_sel:[1,1,0] op_sel_hi:[0,1,1] neg_lo:[1,0,0]
    v_cvt_pk_f16_f32 v82, v94, v95
    ds_write_b32 v79, v82 offset:23232
    v_pk_mul_f32 v[98:99], v[76:77], v[88:89] op_sel:[0,0] op_sel_hi:[1,0]
    v_pk_fma_f32 v[98:99], v[76:77], v[88:89], v[98:99] op_sel:[1,1,0] op_sel_hi:[0,1,1] neg_lo:[1,0,0]
    v_cvt_pk_f16_f32 v83, v98, v99
    ds_write_b32 v79, v83 offset:528
    v_pk_mul_f32 v[108:109], v[106:107], v[106:107] op_sel:[0,0] op_sel_hi:[1,0]
    v_pk_fma_f32 v[108:109], v[106:107], v[106:107], v[108:109] op_sel:[1,1,0] op_sel_hi:[0,1,1] neg_lo:[1,0,0]
    v_cvt_pk_f16_f32 v84, v108, v109
    ds_write_b32 v79, v84 offset:23760
    v_pk_mul_f32 v[102:103], v[92:93], v[88:89] op_sel:[0,0] op_sel_hi:[1,0]
    v_pk_fma_f32 v[102:103], v[92:93], v[88:89], v[102:103] op_sel:[1,1,0] op_sel_hi:[0,1,1] neg_lo:[1,0,0]
    v_cvt_pk_f16_f32 v85, v102, v103
    ds_write_b32 v79, v85 offset:4752
    v_pk_mul_f32 v[96:97], v[94:95], v[106:107] op_sel:[0,0] op_sel_hi:[1,0]
    v_pk_fma_f32 v[96:97], v[94:95], v[106:107], v[96:97] op_sel:[1,1,0] op_sel_hi:[0,1,1] neg_lo:[1,0,0]
    v_cvt_pk_f16_f32 v82, v96, v97
    ds_write_b32 v79, v82 offset:24288
    v_pk_mul_f32 v[100:101], v[98:99], v[88:89] op_sel:[0,0] op_sel_hi:[1,0]
    v_pk_fma_f32 v[100:101], v[98:99], v[88:89], v[100:101] op_sel:[1,1,0] op_sel_hi:[0,1,1] neg_lo:[1,0,0]
    v_cvt_pk_f16_f32 v83, v100, v101
    ds_write_b32 v79, v83 offset:1056
    v_pk_mul_f32 v[110:111], v[108:109], v[106:107] op_sel:[0,0] op_sel_hi:[1,0]
    v_pk_fma_f32 v[110:111], v[108:109], v[106:107], v[110:111] op_sel:[1,1,0] op_sel_hi:[0,1,1] neg_lo:[1,0,0]
    v_cvt_pk_f16_f32 v84, v110, v111
    ds_write_b32 v79, v84 offset:24816
    v_pk_mul_f32 v[104:105], v[102:103], v[88:89] op_sel:[0,0] op_sel_hi:[1,0]
    v_pk_fma_f32 v[104:105], v[102:103], v[88:89], v[104:105] op_sel:[1,1,0] op_sel_hi:[0,1,1] neg_lo:[1,0,0]
    v_cvt_pk_f16_f32 v85, v104, v105
    ds_write_b32 v79, v85 offset:5280
    v_pk_mul_f32 v[94:95], v[96:97], v[106:107] op_sel:[0,0] op_sel_hi:[1,0]
    v_pk_fma_f32 v[94:95], v[96:97], v[106:107], v[94:95] op_sel:[1,1,0] op_sel_hi:[0,1,1] neg_lo:[1,0,0]
    v_cvt_pk_f16_f32 v82, v94, v95
    ds_write_b32 v79, v82 offset:25344
    v_pk_mul_f32 v[98:99], v[100:101], v[88:89] op_sel:[0,0] op_sel_hi:[1,0]
    v_pk_fma_f32 v[98:99], v[100:101], v[88:89], v[98:99] op_sel:[1,1,0] op_sel_hi:[0,1,1] neg_lo:[1,0,0]
    v_cvt_pk_f16_f32 v83, v98, v99
    ds_write_b32 v79, v83 offset:1584
    v_pk_mul_f32 v[108:109], v[110:111], v[106:107] op_sel:[0,0] op_sel_hi:[1,0]
    v_pk_fma_f32 v[108:109], v[110:111], v[106:107], v[108:109] op_sel:[1,1,0] op_sel_hi:[0,1,1] neg_lo:[1,0,0]
    v_cvt_pk_f16_f32 v84, v108, v109
    ds_write_b32 v79, v84 offset:25872
    v_pk_mul_f32 v[102:103], v[104:105], v[88:89] op_sel:[0,0] op_sel_hi:[1,0]
    v_pk_fma_f32 v[102:103], v[104:105], v[88:89], v[102:103] op_sel:[1,1,0] op_sel_hi:[0,1,1] neg_lo:[1,0,0]
    v_cvt_pk_f16_f32 v85, v102, v103
    ds_write_b32 v79, v85 offset:5808
    v_pk_mul_f32 v[96:97], v[94:95], v[106:107] op_sel:[0,0] op_sel_hi:[1,0]
    v_pk_fma_f32 v[96:97], v[94:95], v[106:107], v[96:97] op_sel:[1,1,0] op_sel_hi:[0,1,1] neg_lo:[1,0,0]
    v_cvt_pk_f16_f32 v82, v96, v97
    ds_write_b32 v79, v82 offset:26400
    v_pk_mul_f32 v[100:101], v[98:99], v[88:89] op_sel:[0,0] op_sel_hi:[1,0]
    v_pk_fma_f32 v[100:101], v[98:99], v[88:89], v[100:101] op_sel:[1,1,0] op_sel_hi:[0,1,1] neg_lo:[1,0,0]
    v_cvt_pk_f16_f32 v83, v100, v101
    ds_write_b32 v79, v83 offset:2112
    v_pk_mul_f32 v[110:111], v[108:109], v[106:107] op_sel:[0,0] op_sel_hi:[1,0]
    v_pk_fma_f32 v[110:111], v[108:109], v[106:107], v[110:111] op_sel:[1,1,0] op_sel_hi:[0,1,1] neg_lo:[1,0,0]
    v_cvt_pk_f16_f32 v84, v110, v111
    ds_write_b32 v79, v84 offset:26928
    v_pk_mul_f32 v[104:105], v[102:103], v[88:89] op_sel:[0,0] op_sel_hi:[1,0]
    v_pk_fma_f32 v[104:105], v[102:103], v[88:89], v[104:105] op_sel:[1,1,0] op_sel_hi:[0,1,1] neg_lo:[1,0,0]
    v_cvt_pk_f16_f32 v85, v104, v105
    ds_write_b32 v79, v85 offset:6336
    v_pk_mul_f32 v[94:95], v[96:97], v[106:107] op_sel:[0,0] op_sel_hi:[1,0]
    v_pk_fma_f32 v[94:95], v[96:97], v[106:107], v[94:95] op_sel:[1,1,0] op_sel_hi:[0,1,1] neg_lo:[1,0,0]
    v_cvt_pk_f16_f32 v82, v94, v95
    ds_write_b32 v79, v82 offset:27456
    v_pk_mul_f32 v[98:99], v[100:101], v[88:89] op_sel:[0,0] op_sel_hi:[1,0]
    v_pk_fma_f32 v[98:99], v[100:101], v[88:89], v[98:99] op_sel:[1,1,0] op_sel_hi:[0,1,1] neg_lo:[1,0,0]
    v_cvt_pk_f16_f32 v83, v98, v99
    ds_write_b32 v79, v83 offset:2640
    v_pk_mul_f32 v[108:109], v[110:111], v[106:107] op_sel:[0,0] op_sel_hi:[1,0]
    v_pk_fma_f32 v[108:109], v[110:111], v[106:107], v[108:109] op_sel:[1,1,0] op_sel_hi:[0,1,1] neg_lo:[1,0,0]
    v_cvt_pk_f16_f32 v84, v108, v109
    ds_write_b32 v79, v84 offset:27984
    v_pk_mul_f32 v[102:103], v[104:105], v[88:89] op_sel:[0,0] op_sel_hi:[1,0]
    v_pk_fma_f32 v[102:103], v[104:105], v[88:89], v[102:103] op_sel:[1,1,0] op_sel_hi:[0,1,1] neg_lo:[1,0,0]
    v_cvt_pk_f16_f32 v85, v102, v103
    ds_write_b32 v79, v85 offset:6864
    v_pk_mul_f32 v[96:97], v[94:95], v[106:107] op_sel:[0,0] op_sel_hi:[1,0]
    v_pk_fma_f32 v[96:97], v[94:95], v[106:107], v[96:97] op_sel:[1,1,0] op_sel_hi:[0,1,1] neg_lo:[1,0,0]
    v_cvt_pk_f16_f32 v82, v96, v97
    ds_write_b32 v79, v82 offset:28512
    v_pk_mul_f32 v[100:101], v[98:99], v[88:89] op_sel:[0,0] op_sel_hi:[1,0]
    v_pk_fma_f32 v[100:101], v[98:99], v[88:89], v[100:101] op_sel:[1,1,0] op_sel_hi:[0,1,1] neg_lo:[1,0,0]
    v_cvt_pk_f16_f32 v83, v100, v101
    ds_write_b32 v79, v83 offset:3168
    v_pk_mul_f32 v[110:111], v[108:109], v[106:107] op_sel:[0,0] op_sel_hi:[1,0]
    v_pk_fma_f32 v[110:111], v[108:109], v[106:107], v[110:111] op_sel:[1,1,0] op_sel_hi:[0,1,1] neg_lo:[1,0,0]
    v_cvt_pk_f16_f32 v84, v110, v111
    ds_write_b32 v79, v84 offset:29040
    v_pk_mul_f32 v[104:105], v[102:103], v[88:89] op_sel:[0,0] op_sel_hi:[1,0]
    v_pk_fma_f32 v[104:105], v[102:103], v[88:89], v[104:105] op_sel:[1,1,0] op_sel_hi:[0,1,1] neg_lo:[1,0,0]
    v_cvt_pk_f16_f32 v85, v104, v105
    ds_write_b32 v79, v85 offset:7392
    v_pk_mul_f32 v[94:95], v[96:97], v[106:107] op_sel:[0,0] op_sel_hi:[1,0]
    v_pk_fma_f32 v[94:95], v[96:97], v[106:107], v[94:95] op_sel:[1,1,0] op_sel_hi:[0,1,1] neg_lo:[1,0,0]
    v_cvt_pk_f16_f32 v82, v94, v95
    ds_write_b32 v79, v82 offset:29568
    v_pk_mul_f32 v[98:99], v[100:101], v[88:89] op_sel:[0,0] op_sel_hi:[1,0]
    v_pk_fma_f32 v[98:99], v[100:101], v[88:89], v[98:99] op_sel:[1,1,0] op_sel_hi:[0,1,1] neg_lo:[1,0,0]
    v_cvt_pk_f16_f32 v83, v98, v99
    ds_write_b32 v79, v83 offset:3696
    v_pk_mul_f32 v[102:103], v[104:105], v[88:89] op_sel:[0,0] op_sel_hi:[1,0]
    v_pk_fma_f32 v[102:103], v[104:105], v[88:89], v[102:103] op_sel:[1,1,0] op_sel_hi:[0,1,1] neg_lo:[1,0,0]
    v_cvt_pk_f16_f32 v84, v102, v103
    ds_write_b32 v79, v84 offset:7920
    s_branch L_kga_2
L_set1_1:
    v_mul_f32 v80, 0x40000000, v75
    v_mul_f32 v81, 0x40000000, v74
    v_fract_f32 v80, v80
    v_exp_f32 v81, v81
    v_fmac_f32 v80, 0x40000000, v78
    v_cos_f32 v88, v80
    v_sin_f32 v89, v80
    v_mul_f32 v88, v88, v81
    v_mul_f32 v89, v89, v81
    v_pk_mul_f32 v[86:87], v[90:91], v[90:91] op_sel:[0,0] op_sel_hi:[1,0]
    v_pk_fma_f32 v[86:87], v[90:91], v[90:91], v[86:87] op_sel:[1,1,0] op_sel_hi:[0,1,1] neg_lo:[1,0,0]
    v_pk_mul_f32 v[92:93], v[88:89], v[88:89] op_sel:[0,0] op_sel_hi:[1,0]
    v_pk_fma_f32 v[92:93], v[88:89], v[88:89], v[92:93] op_sel:[1,1,0] op_sel_hi:[0,1,1] neg_lo:[1,0,0]
    v_pk_mul_f32 v[94:95], v[86:87], v[86:87] op_sel:[0,0] op_sel_hi:[1,0]
    v_pk_fma_f32 v[94:95], v[86:87], v[86:87], v[94:95] op_sel:[1,1,0] op_sel_hi:[0,1,1] neg_lo:[1,0,0]
    v_pk_mul_f32 v[96:97], v[76:77], v[86:87] op_sel:[0,0] op_sel_hi:[1,0]
    v_pk_fma_f32 v[96:97], v[76:77], v[86:87], v[96:97] op_sel:[1,1,0] op_sel_hi:[0,1,1] neg_lo:[1,0,0]
    v_cvt_pk_f16_f32 v85, v96, v97
    ds_write_b32 v79, v85 offset:8448
    v_pk_mul_f32 v[98:99], v[94:95], v[94:95] op_sel:[0,0] op_sel_hi:[1,0]
    v_pk_fma_f32 v[98:99], v[94:95], v[94:95], v[98:99] op_sel:[1,1,0] op_sel_hi:[0,1,1] neg_lo:[1,0,0]
    v_pk_mul_f32 v[100:101], v[96:97], v[90:91] op_sel:[0,0] op_sel_hi:[1,0]
    v_pk_fma_f32 v[100:101], v[96:97], v[90:91], v[100:101] op_sel:[1,1,0] op_sel_hi:[0,1,1] neg_lo:[1,0,0]
    v_cvt_pk_f16_f32 v82, v100, v101
    ds_write_b32 v79, v82 offset:10560
    v_pk_mul_f32 v[102:103], v[76:77], v[98:99] op_sel:[0,0] op_sel_hi:[1,0]
    v_pk_fma_f32 v[102:103], v[76:77], v[98:99], v[102:103] op_sel:[1,1,0] op_sel_hi:[0,1,1] neg_lo:[1,0,0]
    v_cvt_pk_f16_f32 v83, v102, v103
    ds_write_b32 v79, v83 offset:16896
    v_pk_mul_f32 v[104:105], v[76:77], v[94:95] op_sel:[0,0] op_sel_hi:[1,0]
    v_pk_fma_f32 v[104:105], v[76:77], v[94:95], v[104:105] op_sel:[1,1,0] op_sel_hi:[0,1,1] neg_lo:[1,0,0]
    v_cvt_pk_f16_f32 v84, v104, v105
    ds_write_b32 v79, v84 offset:12672
    s_load_dwordx4 s[28:31], s[40:41], 0
    v_pk_mul_f32 v[106:107], v[102:103], v[90:91] op_sel:[0,0] op_sel_hi:[1,0]
    v_pk_fma_f32 v[106:107], v[102:103], v[90:91], v[106:107] op_sel:[1,1,0] op_sel_hi:[0,1,1] neg_lo:[1,0,0]
    v_cvt_pk_f16_f32 v85, v106, v107
    ds_write_b32 v79, v85 offset:17424
    v_pk_mul_f32 v[110:111], v[104:105], v[90:91] op_sel:[0,0] op_sel_hi:[1,0]
    v_pk_fma_f32 v[110:111], v[104:105], v[90:91], v[110:111] op_sel:[1,1,0] op_sel_hi:[0,1,1] neg_lo:[1,0,0]
    v_cvt_pk_f16_f32 v82, v110, v111
    ds_write_b32 v79, v82 offset:13728
    v_pk_mul_f32 v[116:117], v[96:97], v[88:89] op_sel:[0,0] op_sel_hi:[1,0]
    v_pk_fma_f32 v[116:117], v[96:97], v[88:89], v[116:117] op_sel:[1,1,0] op_sel_hi:[0,1,1] neg_lo:[1,0,0]
    v_cvt_pk_f16_f32 v83, v116, v117
    ds_write_b32 v79, v83 offset:8976
    v_pk_mul_f32 v[120:121], v[100:101], v[88:89] op_sel:[0,0] op_sel_hi:[1,0]
    v_pk_fma_f32 v[120:121], v[100:101], v[88:89], v[120:121] op_sel:[1,1,0] op_sel_hi:[0,1,1] neg_lo:[1,0,0]
    v_cvt_pk_f16_f32 v84, v120, v121
    ds_write_b32 v79, v84 offset:11088
    v_pk_mul_f32 v[108:109], v[106:107], v[90:91] op_sel:[0,0] op_sel_hi:[1,0]
    v_pk_fma_f32 v[108:109], v[106:107], v[90:91], v[108:109] op_sel:[1,1,0] op_sel_hi:[0,1,1] neg_lo:[1,0,0]
    v_cvt_pk_f16_f32 v85, v108, v109
    ds_write_b32 v79, v85 offset:17952
    v_pk_mul_f32 v[112:113], v[110:111], v[90:91] op_sel:[0,0] op_sel_hi:[1,0]
    v_pk_fma_f32 v[112:113], v[110:111], v[90:91], v[112:113] op_sel:[1,1,0] op_sel_hi:[0,1,1] neg_lo:[1,0,0]
    v_cvt_pk_f16_f32 v82, v112, v113
    ds_write_b32 v79, v82 offset:14784
    v_pk_mul_f32 v[118:119], v[116:117], v[88:89] op_sel:[0,0] op_sel_hi:[1,0]
    v_pk_fma_f32 v[118:119], v[116:117], v[88:89], v[118:119] op_sel:[1,1,0] op_sel_hi:[0,1,1] neg_lo:[1,0,0]
    v_cvt_pk_f16_f32 v83, v118, v119
    ds_write_b32 v79, v83 offset:9504
    v_pk_mul_f32 v[122:123], v[120:121], v[88:89] op_sel:[0,0] op_sel_hi:[1,0]
    v_pk_fma_f32 v[122:123], v[120:121], v[88:89], v[122:123] op_sel:[1,1,0] op_sel_hi:[0,1,1] neg_lo:[1,0,0]
    v_cvt_pk_f16_f32 v84, v122, v123
    ds_write_b32 v79, v84 offset:11616
    v_pk_mul_f32 v[106:107], v[108:109], v[90:91] op_sel:[0,0] op_sel_hi:[1,0]
    v_pk_fma_f32 v[106:107], v[108:109], v[90:91], v[106:107] op_sel:[1,1,0] op_sel_hi:[0,1,1] neg_lo:[1,0,0]
    v_cvt_pk_f16_f32 v85, v106, v107
    ds_write_b32 v79, v85 offset:18480
    v_pk_mul_f32 v[114:115], v[112:113], v[90:91] op_sel:[0,0] op_sel_hi:[1,0]
    v_pk_fma_f32 v[114:115], v[112:113], v[90:91], v[114:115] op_sel:[1,1,0] op_sel_hi:[0,1,1] neg_lo:[1,0,0]
    v_cvt_pk_f16_f32 v82, v114, v115
    ds_write_b32 v79, v82 offset:15840
    v_pk_mul_f32 v[116:117], v[118:119], v[88:89] op_sel:[0,0] op_sel_hi:[1,0]
    v_pk_fma_f32 v[116:117], v[118:119], v[88:89], v[116:117] op_sel:[1,1,0] op_sel_hi:[0,1,1] neg_lo:[1,0,0]
    v_cvt_pk_f16_f32 v83, v116, v117
    ds_write_b32 v79, v83 offset:10032
    v_pk_mul_f32 v[120:121], v[122:123], v[88:89] op_sel:[0,0] op_sel_hi:[1,0]
    v_pk_fma_f32 v[120:121], v[122:123], v[88:89], v[120:121] op_sel:[1,1,0] op_sel_hi:[0,1,1] neg_lo:[1,0,0]
    v_cvt_pk_f16_f32 v84, v120, v121
    ds_write_b32 v79, v84 offset:12144
    v_pk_mul_f32 v[108:109], v[106:107], v[90:91] op_sel:[0,0] op_sel_hi:[1,0]
    v_pk_fma_f32 v[108:109], v[106:107], v[90:91], v[108:109] op_sel:[1,1,0] op_sel_hi:[0,1,1] neg_lo:[1,0,0]
    v_cvt_pk_f16_f32 v85, v108, v109
    ds_write_b32 v79, v85 offset:19008
    v_pk_mul_f32 v[106:107], v[108:109], v[90:91] op_sel:[0,0] op_sel_hi:[1,0]
    v_pk_fma_f32 v[106:107], v[108:109], v[90:91], v[106:107] op_sel:[1,1,0] op_sel_hi:[0,1,1] neg_lo:[1,0,0]
    v_cvt_pk_f16_f32 v82, v106, v107
    ds_write_b32 v79, v82 offset:19536
    v_pk_mul_f32 v[108:109], v[106:107], v[90:91] op_sel:[0,0] op_sel_hi:[1,0]
    v_pk_fma_f32 v[108:109], v[106:107], v[90:91], v[108:109] op_sel:[1,1,0] op_sel_hi:[0,1,1] neg_lo:[1,0,0]
    v_cvt_pk_f16_f32 v83, v108, v109
    ds_write_b32 v79, v83 offset:20064
    v_pk_mul_f32 v[106:107], v[108:109], v[90:91] op_sel:[0,0] op_sel_hi:[1,0]
    v_pk_fma_f32 v[106:107], v[108:109], v[90:91], v[106:107] op_sel:[1,1,0] op_sel_hi:[0,1,1] neg_lo:[1,0,0]
    v_cvt_pk_f16_f32 v84, v106, v107
    ds_write_b32 v79, v84 offset:20592
    v_pk_mul_f32 v[108:109], v[106:107], v[90:91] op_sel:[0,0] op_sel_hi:[1,0]
    v_pk_fma_f32 v[108:109], v[106:107], v[90:91], v[108:109] op_sel:[1,1,0] op_sel_hi:[0,1,1] neg_lo:[1,0,0]
    v_cvt_pk_f16_f32 v85, v108, v109
    ds_write_b32 v79, v85 offset:21120
    v_pk_mul_f32 v[116:117], v[104:105], v[92:93] op_sel:[0,0] op_sel_hi:[1,0]
    v_pk_fma_f32 v[116:117], v[104:105], v[92:93], v[116:117] op_sel:[1,1,0] op_sel_hi:[0,1,1] neg_lo:[1,0,0]
    v_cvt_pk_f16_f32 v82, v116, v117
    ds_write_b32 v79, v82 offset:13200
    v_pk_mul_f32 v[118:119], v[110:111], v[92:93] op_sel:[0,0] op_sel_hi:[1,0]
    v_pk_fma_f32 v[118:119], v[110:111], v[92:93], v[118:119] op_sel:[1,1,0] op_sel_hi:[0,1,1] neg_lo:[1,0,0]
    v_cvt_pk_f16_f32 v83, v118, v119
    ds_write_b32 v79, v83 offset:14256
    v_pk_mul_f32 v[116:117], v[112:113], v[92:93] op_sel:[0,0] op_sel_hi:[1,0]
    v_pk_fma_f32 v[116:117], v[112:113], v[92:93], v[116:117] op_sel:[1,1,0] op_sel_hi:[0,1,1] neg_lo:[1,0,0]
    v_cvt_pk_f16_f32 v84, v116, v117
    ds_write_b32 v79, v84 offset:15312
    v_pk_mul_f32 v[118:119], v[114:115], v[92:93] op_sel:[0,0] op_sel_hi:[1,0]
    v_pk_fma_f32 v[118:119], v[114:115], v[92:93], v[118:119] op_sel:[1,1,0] op_sel_hi:[0,1,1] neg_lo:[1,0,0]
    v_cvt_pk_f16_f32 v85, v118, v119
    ds_write_b32 v79, v85 offset:16368
L_kga_2:
    s_waitcnt lgkmcnt(0)
    s_waitcnt vmcnt(1)
    s_and_b64 s[28:29], s[28:29], s[30:31]
    s_and_b32 s28, s28, s29
    s_cmp_lg_u32 s28, 0x01010101
    s_cbranch_scc1 L_notready2
L_ready2:
    s_barrier
    s_mov_b64 exec, 1
    buffer_atomic_add v253, v252, s[44:47], s77 offen sc1
    s_mov_b64 exec, -1
    s_mov_b32 m0, s27
    s_nop 0
    buffer_load_dwordx4 v28, s[48:51], s26 offen lds
    s_cmp_lt_u32 s3, 6
    s_cselect_b64 exec, -1, 0
    ds_read_b128 v[88:91], v33 offset:0
    ds_read_b128 v[92:95], v32 offset:21648
    ds_read_b128 v[96:99], v33 offset:16
    ds_read_b128 v[100:103], v32 offset:21664
    ds_read_b128 v[104:107], v33 offset:32
    ds_read_b128 v[108:111], v32 offset:21680
    ds_read_b128 v[112:115], v33 offset:48
    ds_read_b128 v[116:119], v32 offset:21696
    ds_read_b128 v[120:123], v33 offset:64
    ds_read_b128 v[124:127], v32 offset:21712
    ds_read_b128 v[128:131], v33 offset:80
    ds_read_b128 v[132:135], v32 offset:21728
    ds_read_b128 v[136:139], v33 offset:96
    ds_read_b128 v[140:143], v32 offset:21744
    ds_read_b128 v[144:147], v33 offset:112
    ds_read_b128 v[148:151], v32 offset:21760
    s_mov_b64 exec, -1
    v_and_b32 v20, 0xffff, v36
    v_lshrrev_b32 v21, 16, v36
    v_and_b32 v22, 0xffff, v37
    v_lshrrev_b32 v23, 16, v37
    v_and_b32 v24, 0xffff, v38
    v_lshrrev_b32 v25, 16, v38
    v_and_b32 v26, 0xffff, v39
    v_lshrrev_b32 v27, 16, v39
    s_waitcnt lgkmcnt(14)
    v_mfma_f32_16x16x32_f16 v[84:87], v[88:91], v[92:95], 0
    s_waitcnt lgkmcnt(12)
    v_mfma_f32_16x16x32_f16 v[84:87], v[96:99], v[100:103], v[84:87]
    s_waitcnt lgkmcnt(10)
    v_mfma_f32_16x16x32_f16 v[84:87], v[104:107], v[108:111], v[84:87]
    s_waitcnt lgkmcnt(8)
    v_mfma_f32_16x16x32_f16 v[84:87], v[112:115], v[116:119], v[84:87]
    s_waitcnt lgkmcnt(6)
    v_mfma_f32_16x16x32_f16 v[84:87], v[120:123], v[124:127], v[84:87]
    s_waitcnt lgkmcnt(4)
    v_mfma_f32_16x16x32_f16 v[84:87], v[128:131], v[132:135], v[84:87]
    s_waitcnt lgkmcnt(2)
    v_mfma_f32_16x16x32_f16 v[84:87], v[136:139], v[140:143], v[84:87]
    s_waitcnt lgkmcnt(0)
    v_mfma_f32_16x16x32_f16 v[84:87], v[144:147], v[148:151], v[84:87]
    s_nop 7
    v_cvt_pk_f16_f32 v82, v84, v85
    v_cvt_pk_f16_f32 v83, v86, v87
    ds_write_b64 v34, v[82:83] offset:61440
    s_waitcnt lgkmcnt(0)
    s_barrier
    ds_read_u16 v80, v20 offset:61440
    ds_read_u16_d16_hi v81, v21 offset:61440
    ds_read_u16 v82, v22 offset:61440
    ds_read_u16_d16_hi v83, v23 offset:61440
    ds_read_u16 v84, v24 offset:61440
    ds_read_u16_d16_hi v85, v25 offset:61440
    ds_read_u16 v86, v26 offset:61440
    ds_read_u16_d16_hi v87, v27 offset:61440
    s_waitcnt lgkmcnt(6)
    v_or_b32 v88, v80, v81
    s_waitcnt lgkmcnt(4)
    v_or_b32 v89, v82, v83
    s_waitcnt lgkmcnt(2)
    v_or_b32 v90, v84, v85
    s_waitcnt lgkmcnt(0)
    v_or_b32 v91, v86, v87
    ds_write_b128 v31, v[88:91]
    ds_read_b32 v230, v230
    v_lshrrev_b32 v231, v231, s73
    v_lshlrev_b32 v231, 16, v231
    s_cmp_ge_u32 s3, 4
    s_waitcnt lgkmcnt(0)
    s_barrier
    s_cbranch_scc1 L_c_help
    ds_read_b64_tr_b16 v[128:129], v232 offset:64
    ds_read_b64_tr_b16 v[130:131], v232 offset:32
    ds_read_b64_tr_b16 v[132:133], v232 offset:0
    ds_read_b64_tr_b16 v[134:135], v232 offset:1088
    ds_read_b64_tr_b16 v[136:137], v232 offset:1056
    ds_read_b64_tr_b16 v[138:139], v232 offset:1024
    ds_read_b64_tr_b16 v[140:141], v232 offset:2112
    ds_read_b64_tr_b16 v[142:143], v232 offset:2080
    ds_read_b64_tr_b16 v[144:145], v232 offset:2048
    ds_read_b64_tr_b16 v[146:147], v232 offset:3136
    ds_read_b64_tr_b16 v[148:149], v232 offset:3104
    ds_read_b64_tr_b16 v[150:151], v232 offset:3072
    ds_read_b64_tr_b16 v[152:153], v232 offset:320
    ds_read_b64_tr_b16 v[154:155], v232 offset:288
    ds_read_b64_tr_b16 v[156:157], v232 offset:256
    ds_read_b64_tr_b16 v[158:159], v232 offset:1344
    ds_read_b64_tr_b16 v[160:161], v232 offset:1312
    ds_read_b64_tr_b16 v[162:163], v232 offset:1280
    ds_read_b64_tr_b16 v[164:165], v232 offset:2368
    ds_read_b64_tr_b16 v[166:167], v232 offset:2336
    ds_read_b64_tr_b16 v[168:169], v232 offset:2304
    ds_read_b64_tr_b16 v[170:171], v232 offset:3392
    ds_read_b64_tr_b16 v[172:173], v232 offset:3360
    ds_read_b64_tr_b16 v[174:175], v232 offset:3328
    ds_read_b64_tr_b16 v[176:177], v232 offset:576
    ds_read_b64_tr_b16 v[178:179], v232 offset:544
    ds_read_b64_tr_b16 v[180:181], v232 offset:512
    ds_read_b64_tr_b16 v[182:183], v232 offset:1600
    ds_read_b64_tr_b16 v[184:185], v232 offset:1568
    ds_read_b64_tr_b16 v[186:187], v232 offset:1536
    ds_read_b64_tr_b16 v[188:189], v232 offset:2624
    ds_read_b64_tr_b16 v[190:191], v232 offset:2592
    ds_read_b64_tr_b16 v[192:193], v232 offset:2560
    ds_read_b64_tr_b16 v[194:195], v232 offset:3648
    ds_read_b64_tr_b16 v[196:197], v232 offset:3616
    ds_read_b64_tr_b16 v[198:199], v232 offset:3584
    ds_read_b64_tr_b16 v[200:201], v232 offset:832
    ds_read_b64_tr_b16 v[202:203], v232 offset:800
    ds_read_b64_tr_b16 v[204:205], v232 offset:768
    ds_read_b64_tr_b16 v[206:207], v232 offset:1856
    ds_read_b64_tr_b16 v[208:209], v232 offset:1824
    ds_read_b64_tr_b16 v[210:211], v232 offset:1792
    ds_read_b64_tr_b16 v[212:213], v232 offset:2880
    ds_read_b64_tr_b16 v[214:215], v232 offset:2848
    ds_read_b64_tr_b16 v[216:217], v232 offset:2816
    ds_read_b64_tr_b16 v[218:219], v232 offset:3904
    ds_read_b64_tr_b16 v[220:221], v232 offset:3872
    ds_read_b64_tr_b16 v[222:223], v232 offset:3840
    v_mov_b32 v52, 0
    v_mov_b32 v53, 0
    v_mov_b32 v58, 0
    v_mov_b32 v59, 0
    v_mov_b32 v64, 0
    v_mov_b32 v65, 0
    v_mov_b32 v70, 0
    v_mov_b32 v71, 0
    v_mov_b32 v76, 0
    v_mov_b32 v77, 0
    v_mov_b32 v82, 0
    v_mov_b32 v83, 0
    v_mov_b32 v88, 0
    v_mov_b32 v89, 0
    v_mov_b32 v94, 0
    v_mov_b32 v95, 0
    s_waitcnt vmcnt(0)
    s_barrier
    v_mov_b32 v249, v1
    v_lshlrev_b32 v248, 4, v1
    v_and_b32 v2, 1, v41
    v_lshrrev_b32 v3, 1, v41
    v_lshlrev_b32 v14, 3, v42
    v_lshl_add_u32 v4, v3, 9, v14
    v_lshl_add_u32 v4, v40, 6, v4
    v_lshl_add_u32 v4, v2, 5, v4
    s_lshl_b32 s11, s10, 11
    s_lshl_b32 s12, s9, 10
    s_add_u32 s30, s11, s12
    s_lshl_b32 s11, s5, 2
    s_add_u32 s11, s11, s10
    s_mul_i32 s29, s11, 34816
    s_add_u32 s29, s29, s12
    s_add_u32 s29, s29, 4718592
    s_mul_i32 s31, s11, 115712
    s_add_u32 s31, s31, 7340032
    s_lshl_b32 s38, s11, 10
    s_add_u32 s38, s38, 15728640
    v_lshl_add_u32 v5, v3, 3, v40
    v_mul_u32_u24 v5, 896, v5
    v_lshl_add_u32 v5, v2, 5, v5
    v_add_u32 v5, v5, v14
    v_lshrrev_b32 v6, 3, v1
    v_and_b32 v7, 7, v1
    v_lshlrev_b32 v15, 2, v2
    v_xor_b32 v7, v7, v15
    v_lshlrev_b32 v7, 4, v7
    v_lshl_add_u32 v6, v6, 10, v7
    v_lshl_add_u32 v7, v3, 12, v6
    s_lshl_b32 s11, s8, 7
    s_lshl_b32 s12, s9, 12
    s_add_u32 s11, s11, s12
    s_lshl_b32 s35, s10, 16
    s_add_u32 s35, s35, s11
    s_add_u32 s35, s35, 1179648
    s_add_u32 s11, s11, s12
    s_lshl_b32 s34, s10, 17
    s_add_u32 s34, s34, s11
    s_add_u32 s34, s34, 786432
    s_lshl_b32 s33, s10, 18
    s_add_u32 s33, s33, s11
    s_mul_i32 s28, s6, 133120
    s_add_u32 s28, s28, s30
    s_add_u32 s28, s28, 15859712
    s_mul_i32 s32, s6, 18432
    s_add_u32 s32, s32, s30
    s_add_u32 s32, s32, 15204352
    s_lshl_b32 s11, s5, 2
    s_lshr_b32 s12, s6, 2
    s_add_u32 s11, s11, s12
    s_and_b32 s12, s6, 3
    s_mul_i32 s36, s11, 34816
    s_lshl_b32 s13, s12, 13
    s_add_u32 s36, s36, s13
    s_lshl_b32 s13, s3, 10
    s_add_u32 s36, s36, s13
    s_add_u32 s36, s36, 4718592
    s_add_u32 s39, s13, 155648
    s_lshl_b32 s37, s11, 10
    s_lshl_b32 s13, s12, 8
    s_add_u32 s37, s37, s13
    s_add_u32 s37, s37, 15728640
    v_and_b32 v8, 1, v1
    v_bfe_u32 v15, v1, 1, 1
    v_lshl_add_u32 v8, v8, 1, v15
    v_lshlrev_b32 v8, 3, v8
    v_lshl_add_u32 v8, v2, 5, v8
    v_lshrrev_b32 v15, 1, v40
    v_lshl_add_u32 v8, v15, 6, v8
    v_lshl_add_u32 v8, v40, 7, v8
    v_lshl_add_u32 v8, v3, 9, v8
    s_mul_i32 s11, s10, 2080
    v_xor_b32 v8, s11, v8
    s_lshl_b32 s16, s5, 8
    s_add_u32 s16, s16, 15630336
    s_lshr_b32 s17, s7, 1
    s_lshl_b32 s17, s17, 8
    s_add_u32 s17, s17, 15630336
    s_lshl_b32 s11, s7, 1
    s_add_u32 s11, s11, s9
    s_mul_i32 s22, s11, 115712
    s_add_u32 s22, s22, 7340032
    s_lshl_b32 s13, s10, 12
    s_add_u32 s74, s22, s13
    s_add_u32 s74, s74, 73728
    s_lshl_b32 s13, s10, 13
    s_add_u32 s23, s22, s13
    s_add_u32 s23, s23, 49152
    s_lshl_b32 s13, s10, 14
    s_add_u32 s22, s22, s13
    s_lshl_b32 s21, s11, 15
    s_mul_i32 s11, s11, 34816
    s_lshl_b32 s12, s8, 2
    s_add_u32 s12, s12, s10
    s_lshl_b32 s13, s12, 5
    s_add_u32 s21, s21, s13
    s_lshl_b32 s12, s12, 10
    s_add_u32 s75, s11, s12
    s_add_u32 s75, s75, 4718592
    s_lshl_b32 s12, s6, 1
    s_add_u32 s12, s12, s9
    s_lshl_b32 s13, s12, 10
    s_add_u32 s82, s13, s31
    s_add_u32 s82, s82, 65536
    s_lshl_b32 s13, s12, 9
    s_add_u32 s79, s13, s31
    s_add_u32 s79, s79, 98304
    s_lshl_b32 s13, s12, 11
    s_add_u32 s31, s13, s31
    v_lshl_add_u32 v9, v2, 12, v14
    v_lshl_add_u32 v9, v3, 10, v9
    v_lshl_add_u32 v9, v40, 7, v9
    v_lshl_add_u32 v15, v2, 1, v15
    v_lshl_add_u32 v9, v15, 5, v9
    s_mul_i32 s11, s9, 49152
    s_add_u32 s11, s11, s24
    v_add_u32 v9, s11, v9
    v_xor_b32 v10, 32, v9
    v_xor_b32 v11, 64, v9
    v_xor_b32 v12, 96, v9
    v_add_u32 v13, s11, v248
    s_and_b32 s11, s2, 0xf8
    s_add_u32 s11, s11, s3
    s_mul_i32 s83, s11, 7168
    s_and_b32 s11, s2, 1
    s_lshl_b32 s11, s11, 9
    s_add_u32 s83, s83, s11
    v_min_u32 v14, 27, v1
    v_lshrrev_b32 v15, 2, v14
    v_and_b32 v14, 3, v14
    v_lshlrev_b32 v14, 7, v14
    v_lshl_add_u32 v14, v15, 10, v14
    s_cmp_ge_u32 s3, 2
    s_cbranch_scc1 L_c_q1
    s_waitcnt lgkmcnt(0)
    s_barrier
    ds_read_b128 v[96:99], v235 offset:0
    ds_read_b128 v[100:103], v236 offset:0
    ds_read_b128 v[104:107], v237 offset:0
    ds_read_b128 v[108:111], v238 offset:0
    ds_read_b128 v[112:115], v235 offset:5136
    ds_read_b128 v[116:119], v236 offset:5136
    ds_read_b128 v[120:123], v237 offset:5136
    ds_read_b128 v[124:127], v238 offset:5136
    s_waitcnt lgkmcnt(7)
    v_mfma_f32_16x16x32_f16 v[48:51], v[130:133], v[96:99], 0
    v_mfma_f32_16x16x32_f16 v[60:63], v[128:131], v[96:99], 0
    v_mfma_f32_16x16x32_f16 v[72:75], v[148:151], v[96:99], 0
    v_mfma_f32_16x16x32_f16 v[84:87], v[146:149], v[96:99], 0
    ds_read_b128 v[96:99], v235 offset:10272
    s_waitcnt lgkmcnt(7)
    v_mfma_f32_16x16x32_f16 v[48:51], v[154:157], v[100:103], v[48:51]
    v_mfma_f32_16x16x32_f16 v[60:63], v[152:155], v[100:103], v[60:63]
    v_mfma_f32_16x16x32_f16 v[72:75], v[172:175], v[100:103], v[72:75]
    v_mfma_f32_16x16x32_f16 v[84:87], v[170:173], v[100:103], v[84:87]
    ds_read_b128 v[100:103], v236 offset:10272
    s_waitcnt lgkmcnt(7)
    v_mfma_f32_16x16x32_f16 v[48:51], v[178:181], v[104:107], v[48:51]
    v_mfma_f32_16x16x32_f16 v[60:63], v[176:179], v[104:107], v[60:63]
    v_mfma_f32_16x16x32_f16 v[72:75], v[196:199], v[104:107], v[72:75]
    v_mfma_f32_16x16x32_f16 v[84:87], v[194:197], v[104:107], v[84:87]
    ds_read_b128 v[104:107], v237 offset:10272
    s_waitcnt lgkmcnt(7)
    v_mfma_f32_16x16x32_f16 v[48:51], v[202:205], v[108:111], v[48:51]
    v_mfma_f32_16x16x32_f16 v[60:63], v[200:203], v[108:111], v[60:63]
    v_mfma_f32_16x16x32_f16 v[72:75], v[220:223], v[108:111], v[72:75]
    v_mfma_f32_16x16x32_f16 v[84:87], v[218:221], v[108:111], v[84:87]
    ds_read_b128 v[108:111], v238 offset:10272
    s_waitcnt lgkmcnt(7)
    v_mfma_f32_16x16x32_f16 v[54:57], v[130:133], v[112:115], 0
    v_mfma_f32_16x16x32_f16 v[66:69], v[128:131], v[112:115], 0
    v_mfma_f32_16x16x32_f16 v[78:81], v[148:151], v[112:115], 0
    v_mfma_f32_16x16x32_f16 v[90:93], v[146:149], v[112:115], 0
    ds_read_b128 v[112:115], v235 offset:15408
    s_waitcnt lgkmcnt(7)
    v_mfma_f32_16x16x32_f16 v[54:57], v[154:157], v[116:119], v[54:57]
    v_mfma_f32_16x16x32_f16 v[66:69], v[152:155], v[116:119], v[66:69]
    v_mfma_f32_16x16x32_f16 v[78:81], v[172:175], v[116:119], v[78:81]
    v_mfma_f32_16x16x32_f16 v[90:93], v[170:173], v[116:119], v[90:93]
    ds_read_b128 v[116:119], v236 offset:15408
    s_waitcnt lgkmcnt(7)
    v_mfma_f32_16x16x32_f16 v[54:57], v[178:181], v[120:123], v[54:57]
    v_mfma_f32_16x16x32_f16 v[66:69], v[176:179], v[120:123], v[66:69]
    v_mfma_f32_16x16x32_f16 v[78:81], v[196:199], v[120:123], v[78:81]
    v_mfma_f32_16x16x32_f16 v[90:93], v[194:197], v[120:123], v[90:93]
    ds_read_b128 v[120:123], v237 offset:15408
    s_waitcnt lgkmcnt(7)
    v_mfma_f32_16x16x32_f16 v[54:57], v[202:205], v[124:127], v[54:57]
    v_mfma_f32_16x16x32_f16 v[66:69], v[200:203], v[124:127], v[66:69]
    v_mfma_f32_16x16x32_f16 v[78:81], v[220:223], v[124:127], v[78:81]
    v_mfma_f32_16x16x32_f16 v[90:93], v[218:221], v[124:127], v[90:93]
    ds_read_b128 v[124:127], v238 offset:15408
    s_waitcnt lgkmcnt(7)
    v_mfma_f32_16x16x32_f16 v[50:53], v[130:133], v[96:99], v[50:53]
    v_mfma_f32_16x16x32_f16 v[62:65], v[128:131], v[96:99], v[62:65]
    v_mfma_f32_16x16x32_f16 v[74:77], v[148:151], v[96:99], v[74:77]
    v_mfma_f32_16x16x32_f16 v[86:89], v[146:149], v[96:99], v[86:89]
    s_barrier
    ds_read_b128 v[36:39], v225
    ds_read_b128 v[44:47], v226
    ds_read_b128 v[96:99], v235 offset:1024
    s_waitcnt lgkmcnt(9)
    v_mfma_f32_16x16x32_f16 v[50:53], v[154:157], v[100:103], v[50:53]
    v_mfma_f32_16x16x32_f16 v[62:65], v[152:155], v[100:103], v[62:65]
    v_mfma_f32_16x16x32_f16 v[74:77], v[172:175], v[100:103], v[74:77]
    v_mfma_f32_16x16x32_f16 v[86:89], v[170:173], v[100:103], v[86:89]
    ds_read_b128 v[100:103], v236 offset:1024
    s_waitcnt lgkmcnt(9)
    v_mfma_f32_16x16x32_f16 v[50:53], v[178:181], v[104:107], v[50:53]
    v_mfma_f32_16x16x32_f16 v[62:65], v[176:179], v[104:107], v[62:65]
    v_mfma_f32_16x16x32_f16 v[74:77], v[196:199], v[104:107], v[74:77]
    v_mfma_f32_16x16x32_f16 v[86:89], v[194:197], v[104:107], v[86:89]
    ds_read_b128 v[104:107], v237 offset:1024
    s_waitcnt lgkmcnt(9)
    v_mfma_f32_16x16x32_f16 v[50:53], v[202:205], v[108:111], v[50:53]
    v_mfma_f32_16x16x32_f16 v[62:65], v[200:203], v[108:111], v[62:65]
    v_mfma_f32_16x16x32_f16 v[74:77], v[220:223], v[108:111], v[74:77]
    v_mfma_f32_16x16x32_f16 v[86:89], v[218:221], v[108:111], v[86:89]
    ds_read_b128 v[108:111], v238 offset:1024
    s_waitcnt lgkmcnt(9)
    v_mfma_f32_16x16x32_f16 v[56:59], v[130:133], v[112:115], v[56:59]
    v_mfma_f32_16x16x32_f16 v[68:71], v[128:131], v[112:115], v[68:71]
    v_mfma_f32_16x16x32_f16 v[80:83], v[148:151], v[112:115], v[80:83]
    v_mfma_f32_16x16x32_f16 v[92:95], v[146:149], v[112:115], v[92:95]
    ds_read_b128 v[112:115], v235 offset:6160
    s_waitcnt lgkmcnt(9)
    v_mfma_f32_16x16x32_f16 v[56:59], v[154:157], v[116:119], v[56:59]
    v_mfma_f32_16x16x32_f16 v[68:71], v[152:155], v[116:119], v[68:71]
    v_mfma_f32_16x16x32_f16 v[80:83], v[172:175], v[116:119], v[80:83]
    v_mfma_f32_16x16x32_f16 v[92:95], v[170:173], v[116:119], v[92:95]
    ds_read_b128 v[116:119], v236 offset:6160
    s_waitcnt lgkmcnt(9)
    v_mfma_f32_16x16x32_f16 v[56:59], v[178:181], v[120:123], v[56:59]
    v_mfma_f32_16x16x32_f16 v[68:71], v[176:179], v[120:123], v[68:71]
    v_mfma_f32_16x16x32_f16 v[80:83], v[196:199], v[120:123], v[80:83]
    v_mfma_f32_16x16x32_f16 v[92:95], v[194:197], v[120:123], v[92:95]
    ds_read_b128 v[120:123], v237 offset:6160
    s_waitcnt lgkmcnt(9)
    v_mfma_f32_16x16x32_f16 v[56:59], v[202:205], v[124:127], v[56:59]
    v_mfma_f32_16x16x32_f16 v[68:71], v[200:203], v[124:127], v[68:71]
    v_mfma_f32_16x16x32_f16 v[80:83], v[220:223], v[124:127], v[80:83]
    v_mfma_f32_16x16x32_f16 v[92:95], v[218:221], v[124:127], v[92:95]
    ds_read_b128 v[124:127], v238 offset:6160
    ds_read_b128 v[146:149], v235 offset:11296
    s_waitcnt lgkmcnt(8)
    v_mfma_f32_16x16x32_f16 v[72:75], v[142:145], v[96:99], v[72:75]
    v_mfma_f32_16x16x32_f16 v[84:87], v[140:143], v[96:99], v[84:87]
    ds_read_b128 v[170:173], v236 offset:11296
    ds_read_b128 v[194:197], v237 offset:11296
    s_waitcnt lgkmcnt(9)
    v_mfma_f32_16x16x32_f16 v[72:75], v[166:169], v[100:103], v[72:75]
    v_fma_mix_f32 v24, v36, v231, 0 op_sel_hi:[1,0,0]
    v_mfma_f32_16x16x32_f16 v[84:87], v[164:167], v[100:103], v[84:87]
    v_fma_mix_f32 v25, v36, v231, 0 op_sel:[1,0,0] op_sel_hi:[1,0,0]
    ds_read_b128 v[218:221], v238 offset:11296
    ds_read_b128 v[96:99], v235 offset:16432
    s_waitcnt lgkmcnt(10)
    v_mfma_f32_16x16x32_f16 v[72:75], v[190:193], v[104:107], v[72:75]
    v_fma_mix_f32 v26, v37, v231, 0 op_sel_hi:[1,0,0]
    v_mfma_f32_16x16x32_f16 v[84:87], v[188:191], v[104:107], v[84:87]
    v_fma_mix_f32 v27, v37, v231, 0 op_sel:[1,0,0] op_sel_hi:[1,0,0]
    ds_read_b128 v[100:103], v236 offset:16432
    ds_read_b128 v[104:107], v237 offset:16432
    s_waitcnt lgkmcnt(11)
    v_mfma_f32_16x16x32_f16 v[72:75], v[214:217], v[108:111], v[72:75]
    v_fma_mix_f32 v28, v38, v231, 0 op_sel_hi:[1,0,0]
    v_mfma_f32_16x16x32_f16 v[84:87], v[212:215], v[108:111], v[84:87]
    v_fma_mix_f32 v29, v38, v231, 0 op_sel:[1,0,0] op_sel_hi:[1,0,0]
    ds_read_b128 v[108:111], v238 offset:16432
    s_waitcnt lgkmcnt(11)
    v_mfma_f32_16x16x32_f16 v[78:81], v[142:145], v[112:115], v[78:81]
    v_fma_mix_f32 v30, v39, v231, 0 op_sel_hi:[1,0,0]
    v_mfma_f32_16x16x32_f16 v[90:93], v[140:143], v[112:115], v[90:93]
    v_fma_mix_f32 v31, v39, v231, 0 op_sel:[1,0,0] op_sel_hi:[1,0,0]
    ds_read_b128 v[112:115], v235 offset:2048
    s_waitcnt lgkmcnt(11)
    v_mfma_f32_16x16x32_f16 v[78:81], v[166:169], v[116:119], v[78:81]
    v_cvt_pk_bf16_f32 v36, v24, v25
    v_mfma_f32_16x16x32_f16 v[90:93], v[164:167], v[116:119], v[90:93]
    v_cvt_pk_bf16_f32 v37, v26, v27
    ds_read_b128 v[116:119], v236 offset:2048
    s_waitcnt lgkmcnt(11)
    v_mfma_f32_16x16x32_f16 v[78:81], v[190:193], v[120:123], v[78:81]
    v_cvt_pk_bf16_f32 v38, v28, v29
    v_mfma_f32_16x16x32_f16 v[90:93], v[188:191], v[120:123], v[90:93]
    v_cvt_pk_bf16_f32 v39, v30, v31
    ds_read_b128 v[120:123], v237 offset:2048
    s_waitcnt lgkmcnt(11)
    v_mfma_f32_16x16x32_f16 v[78:81], v[214:217], v[124:127], v[78:81]
    v_lshlrev_b32 v24, 16, v36
    v_mfma_f32_16x16x32_f16 v[90:93], v[212:215], v[124:127], v[90:93]
    v_and_b32 v25, 0xffff0000, v36
    ds_read_b128 v[124:127], v238 offset:2048
    s_waitcnt lgkmcnt(11)
    v_mfma_f32_16x16x32_f16 v[74:77], v[142:145], v[146:149], v[74:77]
    v_lshlrev_b32 v26, 16, v37
    v_mfma_f32_16x16x32_f16 v[86:89], v[140:143], v[146:149], v[86:89]
    v_and_b32 v27, 0xffff0000, v37
    ds_read_b128 v[146:149], v235 offset:7184
    s_waitcnt lgkmcnt(11)
    v_mfma_f32_16x16x32_f16 v[74:77], v[166:169], v[170:173], v[74:77]
    v_lshlrev_b32 v28, 16, v38
    v_mfma_f32_16x16x32_f16 v[86:89], v[164:167], v[170:173], v[86:89]
    v_and_b32 v29, 0xffff0000, v38
    ds_read_b128 v[170:173], v236 offset:7184
    s_waitcnt lgkmcnt(11)
    v_mfma_f32_16x16x32_f16 v[74:77], v[190:193], v[194:197], v[74:77]
    v_lshlrev_b32 v30, 16, v39
    v_mfma_f32_16x16x32_f16 v[86:89], v[188:191], v[194:197], v[86:89]
    v_and_b32 v31, 0xffff0000, v39
    ds_read_b128 v[194:197], v237 offset:7184
    s_waitcnt lgkmcnt(11)
    v_mfma_f32_16x16x32_f16 v[74:77], v[214:217], v[218:221], v[74:77]
    v_lshlrev_b32 v16, 16, v44
    v_mfma_f32_16x16x32_f16 v[86:89], v[212:215], v[218:221], v[86:89]
    v_and_b32 v17, 0xffff0000, v44
    ds_read_b128 v[218:221], v238 offset:7184
    s_waitcnt lgkmcnt(11)
    v_mfma_f32_16x16x32_f16 v[80:83], v[142:145], v[96:99], v[80:83]
    v_lshlrev_b32 v18, 16, v45
    v_mfma_f32_16x16x32_f16 v[92:95], v[140:143], v[96:99], v[92:95]
    v_and_b32 v19, 0xffff0000, v45
    ds_read_b128 v[96:99], v235 offset:12320
    s_waitcnt lgkmcnt(11)
    v_mfma_f32_16x16x32_f16 v[80:83], v[166:169], v[100:103], v[80:83]
    v_lshlrev_b32 v20, 16, v46
    v_mfma_f32_16x16x32_f16 v[92:95], v[164:167], v[100:103], v[92:95]
    v_and_b32 v21, 0xffff0000, v46
    ds_read_b128 v[100:103], v236 offset:12320
    s_waitcnt lgkmcnt(11)
    v_mfma_f32_16x16x32_f16 v[80:83], v[190:193], v[104:107], v[80:83]
    v_lshlrev_b32 v22, 16, v47
    v_mfma_f32_16x16x32_f16 v[92:95], v[188:191], v[104:107], v[92:95]
    v_and_b32 v23, 0xffff0000, v47
    ds_read_b128 v[104:107], v237 offset:12320
    s_waitcnt lgkmcnt(11)
    v_mfma_f32_16x16x32_f16 v[80:83], v[214:217], v[108:111], v[80:83]
    v_add_f32 v49, v49, v54
    v_mfma_f32_16x16x32_f16 v[92:95], v[212:215], v[108:111], v[92:95]
    v_add_f32 v50, v50, v55
    ds_read_b128 v[108:111], v238 offset:12320
    s_waitcnt lgkmcnt(11)
    v_mfma_f32_16x16x32_f16 v[72:75], v[136:139], v[112:115], v[72:75]
    v_add_f32 v51, v51, v56
    v_mfma_f32_16x16x32_f16 v[84:87], v[134:137], v[112:115], v[84:87]
    v_add_f32 v52, v52, v57
    ds_read_b128 v[112:115], v235 offset:17456
    s_waitcnt lgkmcnt(11)
    v_mfma_f32_16x16x32_f16 v[72:75], v[160:163], v[116:119], v[72:75]
    v_add_f32 v53, v53, v58
    v_mfma_f32_16x16x32_f16 v[84:87], v[158:161], v[116:119], v[84:87]
    v_add_f32 v61, v61, v66
    ds_read_b128 v[116:119], v236 offset:17456
    s_waitcnt lgkmcnt(11)
    v_mfma_f32_16x16x32_f16 v[72:75], v[184:187], v[120:123], v[72:75]
    v_add_f32 v62, v62, v67
    v_mfma_f32_16x16x32_f16 v[84:87], v[182:185], v[120:123], v[84:87]
    v_add_f32 v63, v63, v68
    ds_read_b128 v[120:123], v237 offset:17456
    s_waitcnt lgkmcnt(11)
    v_mfma_f32_16x16x32_f16 v[72:75], v[208:211], v[124:127], v[72:75]
    v_add_f32 v64, v64, v69
    v_mfma_f32_16x16x32_f16 v[84:87], v[206:209], v[124:127], v[84:87]
    v_add_f32 v65, v65, v70
    ds_read_b128 v[124:127], v238 offset:17456
    s_waitcnt lgkmcnt(11)
    v_mfma_f32_16x16x32_f16 v[78:81], v[136:139], v[146:149], v[78:81]
    ds_write_b32 v233, v48 offset:0
    v_mfma_f32_16x16x32_f16 v[90:93], v[134:137], v[146:149], v[90:93]
    ds_write_b32 v233, v49 offset:2320
    ds_read_b128 v[146:149], v235 offset:3072
    s_waitcnt lgkmcnt(13)
    v_mfma_f32_16x16x32_f16 v[78:81], v[160:163], v[170:173], v[78:81]
    ds_write_b32 v233, v50 offset:4736
    v_mfma_f32_16x16x32_f16 v[90:93], v[158:161], v[170:173], v[90:93]
    ds_write_b32 v233, v51 offset:7056
    ds_read_b128 v[170:173], v236 offset:3072
    s_waitcnt lgkmcnt(15)
    v_mfma_f32_16x16x32_f16 v[78:81], v[184:187], v[194:197], v[78:81]
    ds_write_b32 v233, v52 offset:9476
    v_mfma_f32_16x16x32_f16 v[90:93], v[182:185], v[194:197], v[90:93]
    ds_write_b32 v233, v53 offset:11796
    ds_read_b128 v[194:197], v237 offset:3072
    s_waitcnt lgkmcnt(15)
    v_mfma_f32_16x16x32_f16 v[78:81], v[208:211], v[218:221], v[78:81]
    ds_write_b32 v233, v59 offset:14212
    v_mfma_f32_16x16x32_f16 v[90:93], v[206:209], v[218:221], v[90:93]
    ds_write_b32 v233, v60 offset:16
    ds_read_b128 v[218:221], v238 offset:3072
    v_mfma_f32_16x16x32_f16 v[74:77], v[136:139], v[96:99], v[74:77]
    ds_write_b32 v233, v61 offset:2336
    v_mfma_f32_16x16x32_f16 v[86:89], v[134:137], v[96:99], v[86:89]
    ds_write_b32 v233, v62 offset:4752
    ds_read_b128 v[96:99], v235 offset:8208
    v_mfma_f32_16x16x32_f16 v[74:77], v[160:163], v[100:103], v[74:77]
    ds_write_b32 v233, v63 offset:7072
    v_mfma_f32_16x16x32_f16 v[86:89], v[158:161], v[100:103], v[86:89]
    ds_write_b32 v234, v64 offset:9472
    ds_read_b128 v[100:103], v236 offset:8208
    s_waitcnt lgkmcnt(15)
    v_mfma_f32_16x16x32_f16 v[74:77], v[184:187], v[104:107], v[74:77]
    ds_write_b32 v234, v65 offset:11792
    v_mfma_f32_16x16x32_f16 v[86:89], v[182:185], v[104:107], v[86:89]
    ds_write_b32 v234, v71 offset:14208
    ds_read_b128 v[104:107], v237 offset:8208
    v_mfma_f32_16x16x32_f16 v[74:77], v[208:211], v[108:111], v[74:77]
    v_mfma_f32_16x16x32_f16 v[86:89], v[206:209], v[108:111], v[86:89]
    ds_read_b128 v[108:111], v238 offset:8208
    v_mfma_f32_16x16x32_f16 v[80:83], v[136:139], v[112:115], v[80:83]
    v_mfma_f32_16x16x32_f16 v[92:95], v[134:137], v[112:115], v[92:95]
    ds_read_b128 v[112:115], v235 offset:13344
    v_mfma_f32_16x16x32_f16 v[80:83], v[160:163], v[116:119], v[80:83]
    v_mfma_f32_16x16x32_f16 v[92:95], v[158:161], v[116:119], v[92:95]
    ds_read_b128 v[116:119], v236 offset:13344
    v_mfma_f32_16x16x32_f16 v[80:83], v[184:187], v[120:123], v[80:83]
    v_mfma_f32_16x16x32_f16 v[92:95], v[182:185], v[120:123], v[92:95]
    ds_read_b128 v[120:123], v237 offset:13344
    v_mfma_f32_16x16x32_f16 v[80:83], v[208:211], v[124:127], v[80:83]
    v_mfma_f32_16x16x32_f16 v[92:95], v[206:209], v[124:127], v[92:95]
    ds_read_b128 v[124:127], v238 offset:13344
    v_mfma_f32_16x16x32_f16 v[72:75], v[130:133], v[146:149], v[72:75]
    v_mfma_f32_16x16x32_f16 v[84:87], v[128:131], v[146:149], v[84:87]
    ds_read_b128 v[146:149], v235 offset:18480
    s_waitcnt lgkmcnt(15)
    v_mfma_f32_16x16x32_f16 v[72:75], v[154:157], v[170:173], v[72:75]
    v_mfma_f32_16x16x32_f16 v[84:87], v[152:155], v[170:173], v[84:87]
    ds_read_b128 v[170:173], v236 offset:18480
    v_mfma_f32_16x16x32_f16 v[72:75], v[178:181], v[194:197], v[72:75]
    v_mfma_f32_16x16x32_f16 v[84:87], v[176:179], v[194:197], v[84:87]
    ds_read_b128 v[194:197], v237 offset:18480
    v_mfma_f32_16x16x32_f16 v[72:75], v[202:205], v[218:221], v[72:75]
    v_mfma_f32_16x16x32_f16 v[84:87], v[200:203], v[218:221], v[84:87]
    ds_read_b128 v[218:221], v238 offset:18480
    s_waitcnt lgkmcnt(15)
    v_mfma_f32_16x16x32_f16 v[78:81], v[130:133], v[96:99], v[78:81]
    v_mfma_f32_16x16x32_f16 v[90:93], v[128:131], v[96:99], v[90:93]
    s_waitcnt lgkmcnt(12)
    v_mfma_f32_16x16x32_f16 v[78:81], v[154:157], v[100:103], v[78:81]
    v_mfma_f32_16x16x32_f16 v[90:93], v[152:155], v[100:103], v[90:93]
    s_waitcnt lgkmcnt(9)
    v_mfma_f32_16x16x32_f16 v[78:81], v[178:181], v[104:107], v[78:81]
    v_mfma_f32_16x16x32_f16 v[90:93], v[176:179], v[104:107], v[90:93]
    s_waitcnt lgkmcnt(8)
    v_mfma_f32_16x16x32_f16 v[78:81], v[202:205], v[108:111], v[78:81]
    v_mfma_f32_16x16x32_f16 v[90:93], v[200:203], v[108:111], v[90:93]
    s_waitcnt lgkmcnt(7)
    v_mfma_f32_16x16x32_f16 v[74:77], v[130:133], v[112:115], v[74:77]
    v_mfma_f32_16x16x32_f16 v[86:89], v[128:131], v[112:115], v[86:89]
    s_waitcnt lgkmcnt(6)
    v_mfma_f32_16x16x32_f16 v[74:77], v[154:157], v[116:119], v[74:77]
    v_mfma_f32_16x16x32_f16 v[86:89], v[152:155], v[116:119], v[86:89]
    s_waitcnt lgkmcnt(5)
    v_mfma_f32_16x16x32_f16 v[74:77], v[178:181], v[120:123], v[74:77]
    v_mfma_f32_16x16x32_f16 v[86:89], v[176:179], v[120:123], v[86:89]
    s_waitcnt lgkmcnt(4)
    v_mfma_f32_16x16x32_f16 v[74:77], v[202:205], v[124:127], v[74:77]
    v_mfma_f32_16x16x32_f16 v[86:89], v[200:203], v[124:127], v[86:89]
    s_waitcnt lgkmcnt(3)
    v_mfma_f32_16x16x32_f16 v[80:83], v[130:133], v[146:149], v[80:83]
    v_mfma_f32_16x16x32_f16 v[92:95], v[128:131], v[146:149], v[92:95]
    s_waitcnt lgkmcnt(2)
    v_mfma_f32_16x16x32_f16 v[80:83], v[154:157], v[170:173], v[80:83]
    v_mfma_f32_16x16x32_f16 v[92:95], v[152:155], v[170:173], v[92:95]
    s_waitcnt lgkmcnt(1)
    v_mfma_f32_16x16x32_f16 v[80:83], v[178:181], v[194:197], v[80:83]
    v_mfma_f32_16x16x32_f16 v[92:95], v[176:179], v[194:197], v[92:95]
    s_waitcnt lgkmcnt(0)
    v_mfma_f32_16x16x32_f16 v[80:83], v[202:205], v[218:221], v[80:83]
    v_mfma_f32_16x16x32_f16 v[92:95], v[200:203], v[218:221], v[92:95]
    v_add_f32 v73, v73, v78
    v_add_f32 v74, v74, v79
    s_nop 4
    v_add_f32 v75, v75, v80
    v_add_f32 v76, v76, v81
    v_add_f32 v77, v77, v82
    v_add_f32 v85, v85, v90
    v_add_f32 v86, v86, v91
    v_add_f32 v87, v87, v92
    v_add_f32 v88, v88, v93
    v_add_f32 v89, v89, v94
    ds_write_b32 v233, v72 offset:1728
    ds_write_b32 v233, v73 offset:4048
    ds_write_b32 v233, v74 offset:6464
    ds_write_b32 v233, v75 offset:8784
    ds_write_b32 v233, v76 offset:11204
    ds_write_b32 v233, v77 offset:13524
    ds_write_b32 v233, v83 offset:15940
    ds_write_b32 v233, v84 offset:1744
    ds_write_b32 v233, v85 offset:4064
    ds_write_b32 v233, v86 offset:6480
    ds_write_b32 v233, v87 offset:8800
    ds_write_b32 v234, v88 offset:11200
    ds_write_b32 v234, v89 offset:13520
    ds_write_b32 v234, v95 offset:15936
    s_waitcnt lgkmcnt(0)
    s_barrier
    s_branch L_c_join
L_c_q1:
    s_waitcnt lgkmcnt(0)
    s_barrier
    ds_read_b128 v[96:99], v235 offset:0
    ds_read_b128 v[100:103], v236 offset:0
    ds_read_b128 v[104:107], v237 offset:0
    ds_read_b128 v[108:111], v238 offset:0
    ds_read_b128 v[112:115], v235 offset:5136
    ds_read_b128 v[116:119], v236 offset:5136
    ds_read_b128 v[120:123], v237 offset:5136
    ds_read_b128 v[124:127], v238 offset:5136
    ds_read_b128 v[146:149], v235 offset:10272
    ds_read_b128 v[170:173], v236 offset:10272
    s_waitcnt lgkmcnt(9)
    v_mfma_f32_16x16x32_f16 v[48:51], v[136:139], v[96:99], 0
    v_mfma_f32_16x16x32_f16 v[60:63], v[134:137], v[96:99], 0
    v_mfma_f32_16x16x32_f16 v[72:75], v[142:145], v[96:99], 0
    v_mfma_f32_16x16x32_f16 v[84:87], v[140:143], v[96:99], 0
    ds_read_b128 v[194:197], v237 offset:10272
    ds_read_b128 v[218:221], v238 offset:10272
    s_waitcnt lgkmcnt(10)
    v_mfma_f32_16x16x32_f16 v[48:51], v[160:163], v[100:103], v[48:51]
    v_mfma_f32_16x16x32_f16 v[60:63], v[158:161], v[100:103], v[60:63]
    v_mfma_f32_16x16x32_f16 v[72:75], v[166:169], v[100:103], v[72:75]
    v_mfma_f32_16x16x32_f16 v[84:87], v[164:167], v[100:103], v[84:87]
    ds_read_b128 v[96:99], v235 offset:15408
    ds_read_b128 v[100:103], v236 offset:15408
    s_waitcnt lgkmcnt(11)
    v_mfma_f32_16x16x32_f16 v[48:51], v[184:187], v[104:107], v[48:51]
    v_mfma_f32_16x16x32_f16 v[60:63], v[182:185], v[104:107], v[60:63]
    v_mfma_f32_16x16x32_f16 v[72:75], v[190:193], v[104:107], v[72:75]
    v_mfma_f32_16x16x32_f16 v[84:87], v[188:191], v[104:107], v[84:87]
    ds_read_b128 v[104:107], v237 offset:15408
    s_waitcnt lgkmcnt(11)
    v_mfma_f32_16x16x32_f16 v[48:51], v[208:211], v[108:111], v[48:51]
    v_mfma_f32_16x16x32_f16 v[60:63], v[206:209], v[108:111], v[60:63]
    v_mfma_f32_16x16x32_f16 v[72:75], v[214:217], v[108:111], v[72:75]
    v_mfma_f32_16x16x32_f16 v[84:87], v[212:215], v[108:111], v[84:87]
    ds_read_b128 v[108:111], v238 offset:15408
    s_waitcnt lgkmcnt(11)
    v_mfma_f32_16x16x32_f16 v[54:57], v[136:139], v[112:115], 0
    v_mfma_f32_16x16x32_f16 v[66:69], v[134:137], v[112:115], 0
    v_mfma_f32_16x16x32_f16 v[78:81], v[142:145], v[112:115], 0
    v_mfma_f32_16x16x32_f16 v[90:93], v[140:143], v[112:115], 0
    s_waitcnt lgkmcnt(10)
    v_mfma_f32_16x16x32_f16 v[54:57], v[160:163], v[116:119], v[54:57]
    v_mfma_f32_16x16x32_f16 v[66:69], v[158:161], v[116:119], v[66:69]
    v_mfma_f32_16x16x32_f16 v[78:81], v[166:169], v[116:119], v[78:81]
    v_mfma_f32_16x16x32_f16 v[90:93], v[164:167], v[116:119], v[90:93]
    s_waitcnt lgkmcnt(9)
    v_mfma_f32_16x16x32_f16 v[54:57], v[184:187], v[120:123], v[54:57]
    v_mfma_f32_16x16x32_f16 v[66:69], v[182:185], v[120:123], v[66:69]
    v_mfma_f32_16x16x32_f16 v[78:81], v[190:193], v[120:123], v[78:81]
    v_mfma_f32_16x16x32_f16 v[90:93], v[188:191], v[120:123], v[90:93]
    s_waitcnt lgkmcnt(8)
    v_mfma_f32_16x16x32_f16 v[54:57], v[208:211], v[124:127], v[54:57]
    v_mfma_f32_16x16x32_f16 v[66:69], v[206:209], v[124:127], v[66:69]
    v_mfma_f32_16x16x32_f16 v[78:81], v[214:217], v[124:127], v[78:81]
    v_mfma_f32_16x16x32_f16 v[90:93], v[212:215], v[124:127], v[90:93]
    s_waitcnt lgkmcnt(7)
    v_mfma_f32_16x16x32_f16 v[50:53], v[136:139], v[146:149], v[50:53]
    v_mfma_f32_16x16x32_f16 v[62:65], v[134:137], v[146:149], v[62:65]
    v_mfma_f32_16x16x32_f16 v[74:77], v[142:145], v[146:149], v[74:77]
    v_mfma_f32_16x16x32_f16 v[86:89], v[140:143], v[146:149], v[86:89]
    s_barrier
    ds_read_b128 v[36:39], v225
    ds_read_b128 v[44:47], v226
    ds_read_b128 v[112:115], v235 offset:1024
    ds_read_b128 v[116:119], v236 offset:1024
    s_waitcnt lgkmcnt(10)
    v_mfma_f32_16x16x32_f16 v[50:53], v[160:163], v[170:173], v[50:53]
    v_mfma_f32_16x16x32_f16 v[62:65], v[158:161], v[170:173], v[62:65]
    v_mfma_f32_16x16x32_f16 v[74:77], v[166:169], v[170:173], v[74:77]
    v_mfma_f32_16x16x32_f16 v[86:89], v[164:167], v[170:173], v[86:89]
    ds_read_b128 v[120:123], v237 offset:1024
    ds_read_b128 v[124:127], v238 offset:1024
    s_waitcnt lgkmcnt(11)
    v_mfma_f32_16x16x32_f16 v[50:53], v[184:187], v[194:197], v[50:53]
    v_mfma_f32_16x16x32_f16 v[62:65], v[182:185], v[194:197], v[62:65]
    v_mfma_f32_16x16x32_f16 v[74:77], v[190:193], v[194:197], v[74:77]
    v_mfma_f32_16x16x32_f16 v[86:89], v[188:191], v[194:197], v[86:89]
    ds_read_b128 v[146:149], v235 offset:6160
    ds_read_b128 v[170:173], v236 offset:6160
    s_waitcnt lgkmcnt(12)
    v_mfma_f32_16x16x32_f16 v[50:53], v[208:211], v[218:221], v[50:53]
    v_mfma_f32_16x16x32_f16 v[62:65], v[206:209], v[218:221], v[62:65]
    v_mfma_f32_16x16x32_f16 v[74:77], v[214:217], v[218:221], v[74:77]
    v_mfma_f32_16x16x32_f16 v[86:89], v[212:215], v[218:221], v[86:89]
    ds_read_b128 v[194:197], v237 offset:6160
    ds_read_b128 v[218:221], v238 offset:6160
    s_waitcnt lgkmcnt(13)
    v_mfma_f32_16x16x32_f16 v[56:59], v[136:139], v[96:99], v[56:59]
    v_mfma_f32_16x16x32_f16 v[68:71], v[134:137], v[96:99], v[68:71]
    v_mfma_f32_16x16x32_f16 v[80:83], v[142:145], v[96:99], v[80:83]
    v_mfma_f32_16x16x32_f16 v[92:95], v[140:143], v[96:99], v[92:95]
    ds_read_b128 v[96:99], v235 offset:11296
    s_waitcnt lgkmcnt(13)
    v_mfma_f32_16x16x32_f16 v[56:59], v[160:163], v[100:103], v[56:59]
    v_mfma_f32_16x16x32_f16 v[68:71], v[158:161], v[100:103], v[68:71]
    v_mfma_f32_16x16x32_f16 v[80:83], v[166:169], v[100:103], v[80:83]
    v_mfma_f32_16x16x32_f16 v[92:95], v[164:167], v[100:103], v[92:95]
    ds_read_b128 v[100:103], v236 offset:11296
    s_waitcnt lgkmcnt(13)
    v_mfma_f32_16x16x32_f16 v[56:59], v[184:187], v[104:107], v[56:59]
    v_mfma_f32_16x16x32_f16 v[68:71], v[182:185], v[104:107], v[68:71]
    v_mfma_f32_16x16x32_f16 v[80:83], v[190:193], v[104:107], v[80:83]
    v_mfma_f32_16x16x32_f16 v[92:95], v[188:191], v[104:107], v[92:95]
    ds_read_b128 v[104:107], v237 offset:11296
    s_waitcnt lgkmcnt(13)
    v_mfma_f32_16x16x32_f16 v[56:59], v[208:211], v[108:111], v[56:59]
    v_mfma_f32_16x16x32_f16 v[68:71], v[206:209], v[108:111], v[68:71]
    v_mfma_f32_16x16x32_f16 v[80:83], v[214:217], v[108:111], v[80:83]
    v_mfma_f32_16x16x32_f16 v[92:95], v[212:215], v[108:111], v[92:95]
    ds_read_b128 v[108:111], v238 offset:11296
    s_waitcnt lgkmcnt(11)
    v_mfma_f32_16x16x32_f16 v[48:51], v[130:133], v[112:115], v[48:51]
    v_mfma_f32_16x16x32_f16 v[60:63], v[128:131], v[112:115], v[60:63]
    v_mfma_f32_16x16x32_f16 v[72:75], v[136:139], v[112:115], v[72:75]
    v_mfma_f32_16x16x32_f16 v[84:87], v[134:137], v[112:115], v[84:87]
    ds_read_b128 v[112:115], v235 offset:16432
    s_waitcnt lgkmcnt(11)
    v_mfma_f32_16x16x32_f16 v[48:51], v[154:157], v[116:119], v[48:51]
    v_fma_mix_f32 v24, v36, v231, 0 op_sel_hi:[1,0,0]
    v_mfma_f32_16x16x32_f16 v[60:63], v[152:155], v[116:119], v[60:63]
    v_fma_mix_f32 v25, v36, v231, 0 op_sel:[1,0,0] op_sel_hi:[1,0,0]
    v_mfma_f32_16x16x32_f16 v[72:75], v[160:163], v[116:119], v[72:75]
    v_fma_mix_f32 v26, v37, v231, 0 op_sel_hi:[1,0,0]
    v_mfma_f32_16x16x32_f16 v[84:87], v[158:161], v[116:119], v[84:87]
    v_fma_mix_f32 v27, v37, v231, 0 op_sel:[1,0,0] op_sel_hi:[1,0,0]
    ds_read_b128 v[116:119], v236 offset:16432
    s_waitcnt lgkmcnt(11)
    v_mfma_f32_16x16x32_f16 v[48:51], v[178:181], v[120:123], v[48:51]
    v_fma_mix_f32 v28, v38, v231, 0 op_sel_hi:[1,0,0]
    v_mfma_f32_16x16x32_f16 v[60:63], v[176:179], v[120:123], v[60:63]
    v_fma_mix_f32 v29, v38, v231, 0 op_sel:[1,0,0] op_sel_hi:[1,0,0]
    v_mfma_f32_16x16x32_f16 v[72:75], v[184:187], v[120:123], v[72:75]
    v_fma_mix_f32 v30, v39, v231, 0 op_sel_hi:[1,0,0]
    v_mfma_f32_16x16x32_f16 v[84:87], v[182:185], v[120:123], v[84:87]
    v_fma_mix_f32 v31, v39, v231, 0 op_sel:[1,0,0] op_sel_hi:[1,0,0]
    ds_read_b128 v[120:123], v237 offset:16432
    s_waitcnt lgkmcnt(11)
    v_mfma_f32_16x16x32_f16 v[48:51], v[202:205], v[124:127], v[48:51]
    v_cvt_pk_bf16_f32 v36, v24, v25
    v_mfma_f32_16x16x32_f16 v[60:63], v[200:203], v[124:127], v[60:63]
    v_cvt_pk_bf16_f32 v37, v26, v27
    v_mfma_f32_16x16x32_f16 v[72:75], v[208:211], v[124:127], v[72:75]
    v_cvt_pk_bf16_f32 v38, v28, v29
    v_mfma_f32_16x16x32_f16 v[84:87], v[206:209], v[124:127], v[84:87]
    v_cvt_pk_bf16_f32 v39, v30, v31
    ds_read_b128 v[124:127], v238 offset:16432
    s_waitcnt lgkmcnt(11)
    v_mfma_f32_16x16x32_f16 v[54:57], v[130:133], v[146:149], v[54:57]
    v_lshlrev_b32 v24, 16, v36
    v_mfma_f32_16x16x32_f16 v[66:69], v[128:131], v[146:149], v[66:69]
    v_and_b32 v25, 0xffff0000, v36
    v_mfma_f32_16x16x32_f16 v[78:81], v[136:139], v[146:149], v[78:81]
    v_lshlrev_b32 v26, 16, v37
    v_mfma_f32_16x16x32_f16 v[90:93], v[134:137], v[146:149], v[90:93]
    v_and_b32 v27, 0xffff0000, v37
    ds_read_b128 v[146:149], v235 offset:2048
    s_waitcnt lgkmcnt(11)
    v_mfma_f32_16x16x32_f16 v[54:57], v[154:157], v[170:173], v[54:57]
    v_lshlrev_b32 v28, 16, v38
    v_mfma_f32_16x16x32_f16 v[66:69], v[152:155], v[170:173], v[66:69]
    v_and_b32 v29, 0xffff0000, v38
    v_mfma_f32_16x16x32_f16 v[78:81], v[160:163], v[170:173], v[78:81]
    v_lshlrev_b32 v30, 16, v39
    v_mfma_f32_16x16x32_f16 v[90:93], v[158:161], v[170:173], v[90:93]
    v_and_b32 v31, 0xffff0000, v39
    ds_read_b128 v[170:173], v236 offset:2048
    s_waitcnt lgkmcnt(11)
    v_mfma_f32_16x16x32_f16 v[54:57], v[178:181], v[194:197], v[54:57]
    v_lshlrev_b32 v16, 16, v44
    v_mfma_f32_16x16x32_f16 v[66:69], v[176:179], v[194:197], v[66:69]
    v_and_b32 v17, 0xffff0000, v44
    v_mfma_f32_16x16x32_f16 v[78:81], v[184:187], v[194:197], v[78:81]
    v_lshlrev_b32 v18, 16, v45
    v_mfma_f32_16x16x32_f16 v[90:93], v[182:185], v[194:197], v[90:93]
    v_and_b32 v19, 0xffff0000, v45
    ds_read_b128 v[194:197], v237 offset:2048
    s_waitcnt lgkmcnt(11)
    v_mfma_f32_16x16x32_f16 v[54:57], v[202:205], v[218:221], v[54:57]
    v_lshlrev_b32 v20, 16, v46
    v_mfma_f32_16x16x32_f16 v[66:69], v[200:203], v[218:221], v[66:69]
    v_and_b32 v21, 0xffff0000, v46
    v_mfma_f32_16x16x32_f16 v[78:81], v[208:211], v[218:221], v[78:81]
    v_lshlrev_b32 v22, 16, v47
    v_mfma_f32_16x16x32_f16 v[90:93], v[206:209], v[218:221], v[90:93]
    v_and_b32 v23, 0xffff0000, v47
    ds_read_b128 v[218:221], v238 offset:2048
    s_waitcnt lgkmcnt(11)
    v_mfma_f32_16x16x32_f16 v[50:53], v[130:133], v[96:99], v[50:53]
    v_mfma_f32_16x16x32_f16 v[62:65], v[128:131], v[96:99], v[62:65]
    v_mfma_f32_16x16x32_f16 v[74:77], v[136:139], v[96:99], v[74:77]
    v_mfma_f32_16x16x32_f16 v[86:89], v[134:137], v[96:99], v[86:89]
    ds_read_b128 v[96:99], v235 offset:7184
    s_waitcnt lgkmcnt(11)
    v_mfma_f32_16x16x32_f16 v[50:53], v[154:157], v[100:103], v[50:53]
    v_mfma_f32_16x16x32_f16 v[62:65], v[152:155], v[100:103], v[62:65]
    v_mfma_f32_16x16x32_f16 v[74:77], v[160:163], v[100:103], v[74:77]
    v_mfma_f32_16x16x32_f16 v[86:89], v[158:161], v[100:103], v[86:89]
    ds_read_b128 v[100:103], v236 offset:7184
    s_waitcnt lgkmcnt(11)
    v_mfma_f32_16x16x32_f16 v[50:53], v[178:181], v[104:107], v[50:53]
    v_mfma_f32_16x16x32_f16 v[62:65], v[176:179], v[104:107], v[62:65]
    v_mfma_f32_16x16x32_f16 v[74:77], v[184:187], v[104:107], v[74:77]
    v_mfma_f32_16x16x32_f16 v[86:89], v[182:185], v[104:107], v[86:89]
    ds_read_b128 v[104:107], v237 offset:7184
    s_waitcnt lgkmcnt(11)
    v_mfma_f32_16x16x32_f16 v[50:53], v[202:205], v[108:111], v[50:53]
    v_mfma_f32_16x16x32_f16 v[62:65], v[200:203], v[108:111], v[62:65]
    v_mfma_f32_16x16x32_f16 v[74:77], v[208:211], v[108:111], v[74:77]
    v_mfma_f32_16x16x32_f16 v[86:89], v[206:209], v[108:111], v[86:89]
    ds_read_b128 v[108:111], v238 offset:7184
    s_waitcnt lgkmcnt(11)
    v_mfma_f32_16x16x32_f16 v[56:59], v[130:133], v[112:115], v[56:59]
    v_mfma_f32_16x16x32_f16 v[68:71], v[128:131], v[112:115], v[68:71]
    v_mfma_f32_16x16x32_f16 v[80:83], v[136:139], v[112:115], v[80:83]
    v_mfma_f32_16x16x32_f16 v[92:95], v[134:137], v[112:115], v[92:95]
    ds_read_b128 v[112:115], v235 offset:12320
    s_waitcnt lgkmcnt(11)
    v_mfma_f32_16x16x32_f16 v[56:59], v[154:157], v[116:119], v[56:59]
    v_mfma_f32_16x16x32_f16 v[68:71], v[152:155], v[116:119], v[68:71]
    v_mfma_f32_16x16x32_f16 v[80:83], v[160:163], v[116:119], v[80:83]
    v_mfma_f32_16x16x32_f16 v[92:95], v[158:161], v[116:119], v[92:95]
    ds_read_b128 v[116:119], v236 offset:12320
    s_waitcnt lgkmcnt(11)
    v_mfma_f32_16x16x32_f16 v[56:59], v[178:181], v[120:123], v[56:59]
    v_mfma_f32_16x16x32_f16 v[68:71], v[176:179], v[120:123], v[68:71]
    v_mfma_f32_16x16x32_f16 v[80:83], v[184:187], v[120:123], v[80:83]
    v_mfma_f32_16x16x32_f16 v[92:95], v[182:185], v[120:123], v[92:95]
    ds_read_b128 v[120:123], v237 offset:12320
    s_waitcnt lgkmcnt(11)
    v_mfma_f32_16x16x32_f16 v[56:59], v[202:205], v[124:127], v[56:59]
    v_mfma_f32_16x16x32_f16 v[68:71], v[200:203], v[124:127], v[68:71]
    v_mfma_f32_16x16x32_f16 v[80:83], v[208:211], v[124:127], v[80:83]
    v_mfma_f32_16x16x32_f16 v[92:95], v[206:209], v[124:127], v[92:95]
    ds_read_b128 v[124:127], v238 offset:12320
    s_waitcnt lgkmcnt(11)
    v_mfma_f32_16x16x32_f16 v[72:75], v[130:133], v[146:149], v[72:75]
    v_mfma_f32_16x16x32_f16 v[84:87], v[128:131], v[146:149], v[84:87]
    ds_read_b128 v[146:149], v235 offset:17456
    s_waitcnt lgkmcnt(11)
    v_mfma_f32_16x16x32_f16 v[72:75], v[154:157], v[170:173], v[72:75]
    v_mfma_f32_16x16x32_f16 v[84:87], v[152:155], v[170:173], v[84:87]
    ds_read_b128 v[170:173], v236 offset:17456
    s_waitcnt lgkmcnt(11)
    v_mfma_f32_16x16x32_f16 v[72:75], v[178:181], v[194:197], v[72:75]
    v_mfma_f32_16x16x32_f16 v[84:87], v[176:179], v[194:197], v[84:87]
    ds_read_b128 v[194:197], v237 offset:17456
    s_waitcnt lgkmcnt(11)
    v_mfma_f32_16x16x32_f16 v[72:75], v[202:205], v[218:221], v[72:75]
    v_mfma_f32_16x16x32_f16 v[84:87], v[200:203], v[218:221], v[84:87]
    ds_read_b128 v[218:221], v238 offset:17456
    s_waitcnt lgkmcnt(11)
    v_mfma_f32_16x16x32_f16 v[78:81], v[130:133], v[96:99], v[78:81]
    v_add_f32 v49, v49, v54
    v_mfma_f32_16x16x32_f16 v[90:93], v[128:131], v[96:99], v[90:93]
    v_add_f32 v50, v50, v55
    s_waitcnt lgkmcnt(10)
    v_mfma_f32_16x16x32_f16 v[78:81], v[154:157], v[100:103], v[78:81]
    v_add_f32 v51, v51, v56
    v_mfma_f32_16x16x32_f16 v[90:93], v[152:155], v[100:103], v[90:93]
    v_add_f32 v52, v52, v57
    s_waitcnt lgkmcnt(9)
    v_mfma_f32_16x16x32_f16 v[78:81], v[178:181], v[104:107], v[78:81]
    v_add_f32 v53, v53, v58
    v_mfma_f32_16x16x32_f16 v[90:93], v[176:179], v[104:107], v[90:93]
    v_add_f32 v61, v61, v66
    s_waitcnt lgkmcnt(8)
    v_mfma_f32_16x16x32_f16 v[78:81], v[202:205], v[108:111], v[78:81]
    v_add_f32 v62, v62, v67
    v_mfma_f32_16x16x32_f16 v[90:93], v[200:203], v[108:111], v[90:93]
    v_add_f32 v63, v63, v68
    s_waitcnt lgkmcnt(7)
    v_mfma_f32_16x16x32_f16 v[74:77], v[130:133], v[112:115], v[74:77]
    v_add_f32 v64, v64, v69
    v_mfma_f32_16x16x32_f16 v[86:89], v[128:131], v[112:115], v[86:89]
    v_add_f32 v65, v65, v70
    s_waitcnt lgkmcnt(6)
    v_mfma_f32_16x16x32_f16 v[74:77], v[154:157], v[116:119], v[74:77]
    ds_write_b32 v233, v48 offset:576
    v_mfma_f32_16x16x32_f16 v[86:89], v[152:155], v[116:119], v[86:89]
    ds_write_b32 v233, v49 offset:2896
    s_waitcnt lgkmcnt(7)
    v_mfma_f32_16x16x32_f16 v[74:77], v[178:181], v[120:123], v[74:77]
    ds_write_b32 v233, v50 offset:5312
    v_mfma_f32_16x16x32_f16 v[86:89], v[176:179], v[120:123], v[86:89]
    ds_write_b32 v233, v51 offset:7632
    s_waitcnt lgkmcnt(8)
    v_mfma_f32_16x16x32_f16 v[74:77], v[202:205], v[124:127], v[74:77]
    ds_write_b32 v233, v52 offset:10052
    v_mfma_f32_16x16x32_f16 v[86:89], v[200:203], v[124:127], v[86:89]
    ds_write_b32 v233, v53 offset:12372
    s_waitcnt lgkmcnt(9)
    v_mfma_f32_16x16x32_f16 v[80:83], v[130:133], v[146:149], v[80:83]
    ds_write_b32 v233, v59 offset:14788
    v_mfma_f32_16x16x32_f16 v[92:95], v[128:131], v[146:149], v[92:95]
    ds_write_b32 v233, v60 offset:592
    s_waitcnt lgkmcnt(10)
    v_mfma_f32_16x16x32_f16 v[80:83], v[154:157], v[170:173], v[80:83]
    ds_write_b32 v233, v61 offset:2912
    v_mfma_f32_16x16x32_f16 v[92:95], v[152:155], v[170:173], v[92:95]
    ds_write_b32 v233, v62 offset:5328
    s_waitcnt lgkmcnt(11)
    v_mfma_f32_16x16x32_f16 v[80:83], v[178:181], v[194:197], v[80:83]
    ds_write_b32 v233, v63 offset:7648
    v_mfma_f32_16x16x32_f16 v[92:95], v[176:179], v[194:197], v[92:95]
    ds_write_b32 v234, v64 offset:10048
    s_waitcnt lgkmcnt(12)
    v_mfma_f32_16x16x32_f16 v[80:83], v[202:205], v[218:221], v[80:83]
    ds_write_b32 v234, v65 offset:12368
    v_mfma_f32_16x16x32_f16 v[92:95], v[200:203], v[218:221], v[92:95]
    ds_write_b32 v234, v71 offset:14784
    v_add_f32 v73, v73, v78
    v_add_f32 v74, v74, v79
    s_nop 2
    v_add_f32 v75, v75, v80
    v_add_f32 v76, v76, v81
    v_add_f32 v77, v77, v82
    v_add_f32 v85, v85, v90
    v_add_f32 v86, v86, v91
    v_add_f32 v87, v87, v92
    v_add_f32 v88, v88, v93
    v_add_f32 v89, v89, v94
    ds_write_b32 v233, v72 offset:1152
    ds_write_b32 v233, v73 offset:3472
    ds_write_b32 v233, v74 offset:5888
    ds_write_b32 v233, v75 offset:8208
    ds_write_b32 v233, v76 offset:10628
    ds_write_b32 v233, v77 offset:12948
    ds_write_b32 v233, v83 offset:15364
    ds_write_b32 v233, v84 offset:1168
    ds_write_b32 v233, v85 offset:3488
    ds_write_b32 v233, v86 offset:5904
    ds_write_b32 v233, v87 offset:8224
    ds_write_b32 v234, v88 offset:10624
    ds_write_b32 v234, v89 offset:12944
    ds_write_b32 v234, v95 offset:15360
    s_waitcnt lgkmcnt(0)
    s_barrier
    s_branch L_c_join
L_c_help:
    s_cmp_lg_u32 s3, 4
    s_cbranch_scc1 L_h_np
    s_mov_b64 exec, 65535
    s_mov_b32 s12, 0
L_poll_3:
    buffer_load_dword v250, v251, s[44:47], s78 offen sc1
L_poll_3p:
    s_add_u32 s12, s12, 1
    s_waitcnt vmcnt(0)
    v_cmp_gt_u32 vcc, 16, v250
    s_cmp_gt_u32 s12, 1000000
    s_cbranch_scc1 L_pout_4
    s_cbranch_vccz L_pout_4
    s_branch L_poll_3
L_pout_4:
    s_mov_b64 exec, -1
    s_branch L_h_np2
L_h_np:
    s_waitcnt vmcnt(0)
L_h_np2:
    s_barrier
    s_add_u32 m0, s19, 0
    s_add_u32 s11, s18, 0
    buffer_load_dwordx4 v234, s[44:47], s11 offen sc1 lds
    s_add_u32 m0, s19, 1024
    s_add_u32 s11, s18, 1064960
    buffer_load_dwordx4 v234, s[44:47], s11 offen sc1 lds
    s_add_u32 m0, s19, 2048
    s_add_u32 s11, s18, 2129920
    buffer_load_dwordx4 v234, s[44:47], s11 offen sc1 lds
    s_add_u32 m0, s19, 3072
    s_add_u32 s11, s18, 3194880
    buffer_load_dwordx4 v234, s[44:47], s11 offen sc1 lds
    v_mov_b32 v74, 0
    v_mov_b32 v75, 0
    s_mul_i32 s25, s10, 57344
    s_lshl_b32 s12, s6, 7
    s_add_u32 s25, s25, s12
    ds_read_b64_tr_b16 v[200:201], v236
    ds_read_b64_tr_b16 v[202:203], v236 offset:512
    ds_read_b64_tr_b16 v[204:205], v236 offset:2048
    ds_read_b64_tr_b16 v[206:207], v236 offset:2560
    ds_read_b64_tr_b16 v[208:209], v237
    ds_read_b64_tr_b16 v[210:211], v238
    ds_read_b64_tr_b16 v[212:213], v239
    ds_read_b64_tr_b16 v[214:215], v240
    s_mul_i32 s13, s6, 133120
    s_add_u32 s13, s13, 15859712
    s_lshl_b32 s11, s5, 12
    s_lshl_b32 s12, s10, 10
    s_add_u32 s11, s11, s12
    s_lshl_b32 s12, s5, 11
    s_add_u32 s12, s12, 65536
    s_cmp_lt_u32 s10, 2
    s_cselect_b32 s11, s11, s12
    s_cselect_b32 s12, 2, 1
    s_lshl_b32 s12, s12, 10
    s_add_u32 s11, s11, s13
    s_cmp_eq_u32 s10, 3
    s_cselect_b32 s11, 0x7fff0000, s11
    s_add_u32 s12, s12, s11
    v_lshlrev_b32 v34, 4, v1
    s_waitcnt lgkmcnt(0)
    buffer_store_dwordx4 v[208:211], v34, s[44:47], s11 offen sc1
    buffer_store_dwordx4 v[212:215], v34, s[44:47], s12 offen sc1
    s_lshl_b32 s11, s5, 13
    s_lshr_b32 s12, s24, 1
    s_add_u32 s11, s11, s12
    s_add_u32 s11, s11, s13
    s_cmp_lt_u32 s5, 12
    s_cselect_b32 s11, 0x7fff0000, s11
    buffer_store_dwordx4 v[200:203], v34, s[44:47], s11 offen sc1
    buffer_store_dwordx4 v[204:207], v34, s[44:47], s11 offen offset:2048 sc1
    v_dot2c_f32_bf16 v74, s76, v200
    v_dot2c_f32_bf16 v75, s76, v208
    v_dot2c_f32_bf16 v74, s76, v201
    v_dot2c_f32_bf16 v75, s76, v209
    v_dot2c_f32_bf16 v74, s76, v202
    v_dot2c_f32_bf16 v75, s76, v210
    v_dot2c_f32_bf16 v74, s76, v203
    v_dot2c_f32_bf16 v75, s76, v211
    v_dot2c_f32_bf16 v74, s76, v204
    v_dot2c_f32_bf16 v75, s76, v212
    v_dot2c_f32_bf16 v74, s76, v205
    v_dot2c_f32_bf16 v75, s76, v213
    v_dot2c_f32_bf16 v74, s76, v206
    v_dot2c_f32_bf16 v75, s76, v214
    v_dot2c_f32_bf16 v74, s76, v207
    v_dot2c_f32_bf16 v75, s76, v215
    s_mul_i32 s11, s5, 896
    s_mul_i32 s12, s6, 18432
    s_add_u32 s11, s11, s12
    s_lshl_b32 s12, s10, 6
    s_add_u32 s11, s11, s12
    s_add_u32 s11, s11, 15204352
    v_permlane32_swap_b32 v74, v75
    v_add_f32 v74, v74, v75
    v_cvt_pk_bf16_f32 v75, v74, v74
    v_and_b32 v76, 0xffff0000, v75
    v_sub_f32 v74, v74, v76
    v_cvt_pk_bf16_f32 v74, v74, v74
    s_cmp_eq_u32 s10, 3
    s_cselect_b32 exec_hi, 0, -1
    buffer_store_short v75, v235, s[44:47], s11 offen sc1
    buffer_store_short v74, v235, s[44:47], s11 offen offset:448 sc1
    s_mov_b32 exec_hi, -1
    s_lshl_b32 s11, s2, 2
    s_add_u32 s11, s11, s10
    s_mul_i32 s11, s11, 1792
    v_min_u32 v2, 13, v1
    v_lshlrev_b32 v2, 7, v2
    s_waitcnt vmcnt(9)
    s_barrier
    s_setprio 0
    s_mov_b32 s49, s11
    v_mov_b32 v35, v2
    s_add_u32 m0, s24, 0
    s_add_u32 s27, s25, 28672
    buffer_load_dwordx4 v232, s[64:67], s25 offen lds
    s_add_u32 m0, s24, 1024
    s_nop 0
    buffer_load_dwordx4 v232, s[64:67], s27 offen lds
    s_add_u32 m0, s24, 4096
    s_nop 0
    buffer_load_dwordx4 v233, s[68:71], s25 offen lds
    s_add_u32 m0, s24, 5120
    s_add_u32 s25, s25, 229376
    buffer_load_dwordx4 v233, s[68:71], s27 offen lds
    s_waitcnt vmcnt(10)
    s_barrier
    ds_read_b128 v[36:39], v225
    ds_read_b128 v[44:47], v226
    s_add_u32 m0, s24, 16384
    s_add_u32 s27, s25, 28672
    buffer_load_dwordx4 v232, s[64:67], s25 offen lds
    s_add_u32 m0, s24, 17408
    s_nop 0
    buffer_load_dwordx4 v232, s[64:67], s27 offen lds
    s_add_u32 m0, s24, 20480
    s_nop 0
    buffer_load_dwordx4 v233, s[68:71], s25 offen lds
    s_add_u32 m0, s24, 21504
    s_add_u32 s25, s25, 229376
    buffer_load_dwordx4 v233, s[68:71], s27 offen lds
    s_add_u32 m0, s24, 32768
    s_add_u32 s27, s25, 28672
    buffer_load_dwordx4 v232, s[64:67], s25 offen lds
    s_add_u32 m0, s24, 33792
    s_nop 0
    buffer_load_dwordx4 v232, s[64:67], s27 offen lds
    s_add_u32 m0, s24, 36864
    s_nop 0
    buffer_load_dwordx4 v233, s[68:71], s25 offen lds
    s_add_u32 m0, s24, 37888
    s_add_u32 s25, s25, 229376
    buffer_load_dwordx4 v233, s[68:71], s27 offen lds
    s_add_u32 m0, s24, 49152
    s_add_u32 s27, s25, 28672
    buffer_load_dwordx4 v232, s[64:67], s25 offen lds
    s_add_u32 m0, s24, 50176
    s_nop 0
    buffer_load_dwordx4 v232, s[64:67], s27 offen lds
    s_add_u32 m0, s24, 53248
    s_nop 0
    buffer_load_dwordx4 v233, s[68:71], s25 offen lds
    s_add_u32 m0, s24, 54272
    s_add_u32 s25, s25, 229376
    buffer_load_dwordx4 v233, s[68:71], s27 offen lds
    s_add_u32 m0, s24, 65536
    s_add_u32 s27, s25, 28672
    buffer_load_dwordx4 v232, s[64:67], s25 offen lds
    s_add_u32 m0, s24, 66560
    s_nop 0
    buffer_load_dwordx4 v232, s[64:67], s27 offen lds
    s_add_u32 m0, s24, 69632
    s_nop 0
    buffer_load_dwordx4 v233, s[68:71], s25 offen lds
    s_add_u32 m0, s24, 70656
    s_add_u32 s25, s25, 229376
    buffer_load_dwordx4 v233, s[68:71], s27 offen lds
    s_add_u32 m0, s24, 81920
    s_add_u32 s27, s25, 28672
    buffer_load_dwordx4 v232, s[64:67], s25 offen lds
    s_add_u32 m0, s24, 82944
    s_nop 0
    buffer_load_dwordx4 v232, s[64:67], s27 offen lds
    s_add_u32 m0, s24, 86016
    s_nop 0
    buffer_load_dwordx4 v233, s[68:71], s25 offen lds
    s_add_u32 m0, s24, 87040
    s_add_u32 s25, s25, 229376
    buffer_load_dwordx4 v233, s[68:71], s27 offen lds
    buffer_load_dword v254, v35, s[52:55], s49 offen
    v_mov_b32 v249, v1
    v_lshlrev_b32 v248, 4, v1
    v_and_b32 v2, 1, v41
    v_lshrrev_b32 v3, 1, v41
    v_lshlrev_b32 v14, 3, v42
    v_lshl_add_u32 v4, v3, 9, v14
    v_lshl_add_u32 v4, v40, 6, v4
    v_lshl_add_u32 v4, v2, 5, v4
    s_lshl_b32 s11, s10, 11
    s_lshl_b32 s12, s9, 10
    s_add_u32 s30, s11, s12
    s_lshl_b32 s11, s5, 2
    s_add_u32 s11, s11, s10
    s_mul_i32 s29, s11, 34816
    s_add_u32 s29, s29, s12
    s_add_u32 s29, s29, 4718592
    s_mul_i32 s31, s11, 115712
    s_add_u32 s31, s31, 7340032
    s_lshl_b32 s38, s11, 10
    s_add_u32 s38, s38, 15728640
    v_lshl_add_u32 v5, v3, 3, v40
    v_mul_u32_u24 v5, 896, v5
    v_lshl_add_u32 v5, v2, 5, v5
    v_add_u32 v5, v5, v14
    v_lshrrev_b32 v6, 3, v1
    v_and_b32 v7, 7, v1
    v_lshlrev_b32 v15, 2, v2
    v_xor_b32 v7, v7, v15
    v_lshlrev_b32 v7, 4, v7
    v_lshl_add_u32 v6, v6, 10, v7
    v_lshl_add_u32 v7, v3, 12, v6
    s_lshl_b32 s11, s8, 7
    s_lshl_b32 s12, s9, 12
    s_add_u32 s11, s11, s12
    s_lshl_b32 s35, s10, 16
    s_add_u32 s35, s35, s11
    s_add_u32 s35, s35, 1179648
    s_add_u32 s11, s11, s12
    s_lshl_b32 s34, s10, 17
    s_add_u32 s34, s34, s11
    s_add_u32 s34, s34, 786432
    s_lshl_b32 s33, s10, 18
    s_add_u32 s33, s33, s11
    s_mul_i32 s28, s6, 133120
    s_add_u32 s28, s28, s30
    s_add_u32 s28, s28, 15859712
    s_mul_i32 s32, s6, 18432
    s_add_u32 s32, s32, s30
    s_add_u32 s32, s32, 15204352
    s_lshl_b32 s11, s5, 2
    s_lshr_b32 s12, s6, 2
    s_add_u32 s11, s11, s12
    s_and_b32 s12, s6, 3
    s_mul_i32 s36, s11, 34816
    s_lshl_b32 s13, s12, 13
    s_add_u32 s36, s36, s13
    s_lshl_b32 s13, s3, 10
    s_add_u32 s36, s36, s13
    s_add_u32 s36, s36, 4718592
    s_add_u32 s39, s13, 155648
    s_lshl_b32 s37, s11, 10
    s_lshl_b32 s13, s12, 8
    s_add_u32 s37, s37, s13
    s_add_u32 s37, s37, 15728640
    v_and_b32 v8, 1, v1
    v_bfe_u32 v15, v1, 1, 1
    v_lshl_add_u32 v8, v8, 1, v15
    v_lshlrev_b32 v8, 3, v8
    v_lshl_add_u32 v8, v2, 5, v8
    v_lshrrev_b32 v15, 1, v40
    v_lshl_add_u32 v8, v15, 6, v8
    v_lshl_add_u32 v8, v40, 7, v8
    v_lshl_add_u32 v8, v3, 9, v8
    s_mul_i32 s11, s10, 2080
    v_xor_b32 v8, s11, v8
    s_lshl_b32 s16, s5, 8
    s_add_u32 s16, s16, 15630336
    s_lshr_b32 s17, s7, 1
    s_lshl_b32 s17, s17, 8
    s_add_u32 s17, s17, 15630336
    s_lshl_b32 s11, s7, 1
    s_add_u32 s11, s11, s9
    s_mul_i32 s22, s11, 115712
    s_add_u32 s22, s22, 7340032
    s_lshl_b32 s13, s10, 12
    s_add_u32 s74, s22, s13
    s_add_u32 s74, s74, 73728
    s_lshl_b32 s13, s10, 13
    s_add_u32 s23, s22, s13
    s_add_u32 s23, s23, 49152
    s_lshl_b32 s13, s10, 14
    s_add_u32 s22, s22, s13
    s_lshl_b32 s21, s11, 15
    s_mul_i32 s11, s11, 34816
    s_lshl_b32 s12, s8, 2
    s_add_u32 s12, s12, s10
    s_lshl_b32 s13, s12, 5
    s_add_u32 s21, s21, s13
    s_lshl_b32 s12, s12, 10
    s_add_u32 s75, s11, s12
    s_add_u32 s75, s75, 4718592
    s_lshl_b32 s12, s6, 1
    s_add_u32 s12, s12, s9
    s_lshl_b32 s13, s12, 10
    s_add_u32 s82, s13, s31
    s_add_u32 s82, s82, 65536
    s_lshl_b32 s13, s12, 9
    s_add_u32 s79, s13, s31
    s_add_u32 s79, s79, 98304
    s_lshl_b32 s13, s12, 11
    s_add_u32 s31, s13, s31
    v_lshl_add_u32 v9, v2, 12, v14
    v_lshl_add_u32 v9, v3, 10, v9
    v_lshl_add_u32 v9, v40, 7, v9
    v_lshl_add_u32 v15, v2, 1, v15
    v_lshl_add_u32 v9, v15, 5, v9
    s_mul_i32 s11, s9, 49152
    s_add_u32 s11, s11, s24
    v_add_u32 v9, s11, v9
    v_xor_b32 v10, 32, v9
    v_xor_b32 v11, 64, v9
    v_xor_b32 v12, 96, v9
    v_add_u32 v13, s11, v248
    s_and_b32 s11, s2, 0xf8
    s_add_u32 s11, s11, s3
    s_mul_i32 s83, s11, 7168
    s_and_b32 s11, s2, 1
    s_lshl_b32 s11, s11, 9
    s_add_u32 s83, s83, s11
    v_min_u32 v14, 27, v1
    v_lshrrev_b32 v15, 2, v14
    v_and_b32 v14, 3, v14
    v_lshlrev_b32 v14, 7, v14
    v_lshl_add_u32 v14, v15, 10, v14
    s_waitcnt lgkmcnt(0)
    v_fma_mix_f32 v24, v36, v231, 0 op_sel_hi:[1,0,0]
    v_fma_mix_f32 v25, v36, v231, 0 op_sel:[1,0,0] op_sel_hi:[1,0,0]
    v_fma_mix_f32 v26, v37, v231, 0 op_sel_hi:[1,0,0]
    v_fma_mix_f32 v27, v37, v231, 0 op_sel:[1,0,0] op_sel_hi:[1,0,0]
    v_fma_mix_f32 v28, v38, v231, 0 op_sel_hi:[1,0,0]
    v_fma_mix_f32 v29, v38, v231, 0 op_sel:[1,0,0] op_sel_hi:[1,0,0]
    v_fma_mix_f32 v30, v39, v231, 0 op_sel_hi:[1,0,0]
    v_fma_mix_f32 v31, v39, v231, 0 op_sel:[1,0,0] op_sel_hi:[1,0,0]
    v_cvt_pk_bf16_f32 v36, v24, v25
    v_cvt_pk_bf16_f32 v37, v26, v27
    v_cvt_pk_bf16_f32 v38, v28, v29
    v_cvt_pk_bf16_f32 v39, v30, v31
    v_lshlrev_b32 v24, 16, v36
    v_and_b32 v25, 0xffff0000, v36
    v_lshlrev_b32 v26, 16, v37
    v_and_b32 v27, 0xffff0000, v37
    v_lshlrev_b32 v28, 16, v38
    v_and_b32 v29, 0xffff0000, v38
    v_lshlrev_b32 v30, 16, v39
    v_and_b32 v31, 0xffff0000, v39
    v_lshlrev_b32 v16, 16, v44
    v_and_b32 v17, 0xffff0000, v44
    v_lshlrev_b32 v18, 16, v45
    v_and_b32 v19, 0xffff0000, v45
    v_lshlrev_b32 v20, 16, v46
    v_and_b32 v21, 0xffff0000, v46
    v_lshlrev_b32 v22, 16, v47
    v_and_b32 v23, 0xffff0000, v47
    s_setprio 0
    s_barrier
L_c_join:
    ds_read_b128 v[48:51], v227
    ds_read_b128 v[56:59], v228
    ds_read_b128 v[52:55], v227 offset:16
    ds_read_b128 v[60:63], v228 offset:16
    s_waitcnt lgkmcnt(2)
    v_add_f32 v48, v48, v56
    v_add_f32 v49, v49, v57
    v_add_f32 v50, v50, v58
    v_add_f32 v51, v51, v59
    v_mul_f32 v48, v48, v230
    v_mul_f32 v49, v49, v230
    v_mul_f32 v50, v50, v230
    v_mul_f32 v51, v51, v230
    s_waitcnt lgkmcnt(0)
    v_add_f32 v52, v52, v60
    v_add_f32 v53, v53, v61
    v_add_f32 v54, v54, v62
    v_add_f32 v55, v55, v63
    v_mul_f32 v52, v52, v230
    v_mul_f32 v53, v53, v230
    v_mul_f32 v54, v54, v230
    v_mul_f32 v55, v55, v230
    v_cvt_pk_bf16_f32 v56, v48, v49
    v_cvt_pk_bf16_f32 v57, v50, v51
    v_cvt_pk_bf16_f32 v58, v52, v53
    v_cvt_pk_bf16_f32 v59, v54, v55
    v_dot2c_f32_bf16 v24, s80, v56
    v_dot2c_f32_bf16 v25, s81, v56
    v_dot2c_f32_bf16 v26, s80, v57
    v_dot2c_f32_bf16 v27, s81, v57
    v_dot2c_f32_bf16 v28, s80, v58
    v_dot2c_f32_bf16 v29, s81, v58
    v_dot2c_f32_bf16 v30, s80, v59
    v_dot2c_f32_bf16 v31, s81, v59
    v_cvt_pk_bf16_f32 v56, v24, v25
    v_cvt_pk_bf16_f32 v57, v26, v27
    v_cvt_pk_bf16_f32 v58, v28, v29
    v_cvt_pk_bf16_f32 v59, v30, v31
    v_dot2c_f32_bf16 v16, s80, v56
    v_dot2c_f32_bf16 v17, s81, v56
    v_dot2c_f32_bf16 v18, s80, v57
    v_dot2c_f32_bf16 v19, s81, v57
    v_dot2c_f32_bf16 v20, s80, v58
    v_dot2c_f32_bf16 v21, s81, v58
    v_dot2c_f32_bf16 v22, s80, v59
    v_dot2c_f32_bf16 v23, s81, v59
    v_cvt_pk_bf16_f32 v56, v16, v17
    v_cvt_pk_bf16_f32 v57, v18, v19
    v_cvt_pk_bf16_f32 v58, v20, v21
    v_cvt_pk_bf16_f32 v59, v22, v23
    buffer_store_dwordx4 v[56:59], v229, s[44:47], s20 offen sc1
    v_mov_b32 v2, v232
    v_mov_b32 v3, v233
    s_lshl_b32 s11, s10, 11
    v_add_u32 v216, s11, v4
    v_add_u32 v217, 57344, v216
    v_add_u32 v218, 106496, v216
    v_mov_b32 v220, v248
    v_add_u32 v221, 57344, v248
    v_add_u32 v222, 106496, v248
    v_add_u32 v229, 147456, v5
    v_mov_b32 v227, v6
    v_mov_b32 v228, v7
    v_lshlrev_b32 v235, 2, v1
    v_add_u32 v233, s39, v4
    v_add_u32 v234, s39, v235
    v_add_u32 v232, 155648, v235
    v_mov_b32 v230, v4
    v_xor_b32 v255, 64, v8
    v_add_u32 v223, 57344, v8
    v_add_u32 v224, 106496, v8
    v_add_u32 v225, 57344, v255
    v_add_u32 v226, 106496, v255
    s_lshl_b32 s11, s3, 11
    v_add_u32 v238, s11, v248
    v_xor_b32 v239, 8192, v238
    s_cmp_lg_u32 s9, 0
    s_waitcnt vmcnt(0)
    s_barrier
    s_mov_b64 exec, 1
    buffer_atomic_add v253, v252, s[44:47], s77 offen sc1
    s_mov_b64 exec, -1
    ds_read_b64_tr_b16 v[128:129], v9 offset:0
    ds_read_b64_tr_b16 v[130:131], v9 offset:512
    ds_read_b64_tr_b16 v[132:133], v10 offset:0
    ds_read_b64_tr_b16 v[134:135], v10 offset:512
    ds_read_b64_tr_b16 v[136:137], v11 offset:0
    ds_read_b64_tr_b16 v[138:139], v11 offset:512
    ds_read_b64_tr_b16 v[140:141], v12 offset:0
    ds_read_b64_tr_b16 v[142:143], v12 offset:512
    ds_read_b64_tr_b16 v[144:145], v9 offset:16384
    ds_read_b64_tr_b16 v[146:147], v9 offset:16896
    ds_read_b64_tr_b16 v[148:149], v10 offset:16384
    ds_read_b64_tr_b16 v[150:151], v10 offset:16896
    ds_read_b64_tr_b16 v[152:153], v11 offset:16384
    ds_read_b64_tr_b16 v[154:155], v11 offset:16896
    ds_read_b64_tr_b16 v[156:157], v12 offset:16384
    ds_read_b64_tr_b16 v[158:159], v12 offset:16896
    ds_read_b64_tr_b16 v[160:161], v9 offset:32768
    ds_read_b64_tr_b16 v[162:163], v9 offset:33280
    ds_read_b64_tr_b16 v[164:165], v10 offset:32768
    ds_read_b64_tr_b16 v[166:167], v10 offset:33280
    ds_read_b64_tr_b16 v[168:169], v11 offset:32768
    ds_read_b64_tr_b16 v[170:171], v11 offset:33280
    ds_read_b64_tr_b16 v[172:173], v12 offset:32768
    ds_read_b64_tr_b16 v[174:175], v12 offset:33280
    s_waitcnt lgkmcnt(15)
    ds_write_b128 v13, v[128:131] offset:0
    ds_write_b128 v13, v[132:135] offset:1024
    ds_write_b128 v13, v[136:139] offset:4096
    ds_write_b128 v13, v[140:143] offset:5120
    s_waitcnt lgkmcnt(12)
    ds_write_b128 v13, v[144:147] offset:16384
    ds_write_b128 v13, v[148:151] offset:17408
    ds_write_b128 v13, v[152:155] offset:20480
    ds_write_b128 v13, v[156:159] offset:21504
    s_waitcnt lgkmcnt(8)
    ds_write_b128 v13, v[160:163] offset:32768
    ds_write_b128 v13, v[164:167] offset:33792
    ds_write_b128 v13, v[168:171] offset:36864
    ds_write_b128 v13, v[172:175] offset:37888
    v_mov_b32 v254, v8
    v_mov_b32 v176, 0
    v_mov_b32 v177, 0
    s_cmp_lg_u32 s9, 0
    s_cbranch_scc1 L_g1_p1
    s_waitcnt lgkmcnt(0)
    s_cmp_lg_u32 s3, 0
    s_cbranch_scc1 L_g1_nopoll
    s_mov_b64 exec, 65535
    s_mov_b32 s12, 0
L_poll_5:
    buffer_load_dword v250, v251, s[44:47], s78 offen sc1
L_poll_5p:
    s_add_u32 s12, s12, 1
    s_waitcnt vmcnt(0)
    v_cmp_gt_u32 vcc, 32, v250
    s_cmp_gt_u32 s12, 1000000
    s_cbranch_scc1 L_pout_6
    s_cbranch_vccz L_pout_6
    s_branch L_poll_5
L_pout_6:
    s_mov_b64 exec, -1
L_g1_nopoll:
    s_barrier
    s_add_u32 m0, s30, 98304
    s_add_u32 s11, s29, 0
    buffer_load_dwordx4 v248, s[44:47], s11 offen sc1 lds
    s_add_u32 m0, s30, 106496
    s_add_u32 s11, s29, 2048
    buffer_load_dwordx4 v248, s[44:47], s11 offen sc1 lds
    s_barrier
    s_add_u32 m0, s30, 114688
    s_add_u32 s11, s29, 4096
    buffer_load_dwordx4 v248, s[44:47], s11 offen sc1 lds
    s_add_u32 m0, s30, 122880
    s_add_u32 s11, s29, 6144
    buffer_load_dwordx4 v248, s[44:47], s11 offen sc1 lds
    s_mov_b32 m0, s39
    s_nop 0
    buffer_load_dwordx4 v248, s[44:47], s36 offen sc1 lds
    ds_read_b128 v[192:195], v220 offset:0
    ds_read_b128 v[196:199], v220 offset:1024
    ds_read_b128 v[200:203], v220 offset:2048
    ds_read_b128 v[204:207], v220 offset:3072
    s_waitcnt vmcnt(4)
    s_barrier
    ds_read_b64_tr_b16 v[0:1], v217 offset:40960
    ds_read_b64_tr_b16 v[2:3], v217 offset:41216
    ds_read_b64_tr_b16 v[4:5], v217 offset:41984
    ds_read_b64_tr_b16 v[6:7], v217 offset:42240
    s_waitcnt lgkmcnt(2)
    s_waitcnt vmcnt(3)
    s_barrier
    v_mfma_f32_32x32x16_bf16 v[128:143], v[192:195], v[0:3], 0
    ds_read_b128 v[208:211], v220 offset:8192
    ds_read_b64_tr_b16 v[8:9], v218 offset:0
    s_add_u32 m0, s30, 147456
    s_add_u32 s11, s29, 8192
    buffer_load_dwordx4 v248, s[44:47], s11 offen sc1 lds
    v_mfma_f32_32x32x16_bf16 v[144:159], v[196:199], v[0:3], 0
    ds_read_b128 v[212:215], v220 offset:9216
    ds_read_b64_tr_b16 v[10:11], v218 offset:256
    s_waitcnt lgkmcnt(4)
    v_mfma_f32_32x32x16_bf16 v[128:143], v[200:203], v[4:7], v[128:143]
    ds_read_b128 v[192:195], v220 offset:10240
    ds_read_b64_tr_b16 v[12:13], v218 offset:1024
    s_add_u32 m0, s30, 139264
    s_add_u32 s11, s29, 10240
    buffer_load_dwordx4 v248, s[44:47], s11 offen sc1 lds
    v_mfma_f32_32x32x16_bf16 v[144:159], v[204:207], v[4:7], v[144:159]
    ds_read_b128 v[196:199], v220 offset:11264
    ds_read_b64_tr_b16 v[14:15], v218 offset:1280
    s_add_u32 m0, s30, 131072
    s_add_u32 s11, s29, 12288
    buffer_load_dwordx4 v248, s[44:47], s11 offen sc1 lds
    s_waitcnt lgkmcnt(4)
    s_waitcnt vmcnt(4)
    s_barrier
    s_waitcnt vmcnt(3)
    v_mfma_f32_32x32x16_bf16 v[128:143], v[208:211], v[8:11], v[128:143]
    ds_read_b128 v[200:203], v220 offset:16384
    ds_read_b64_tr_b16 v[16:17], v218 offset:8192
    s_add_u32 m0, s30, 98304
    s_add_u32 s11, s29, 14336
    buffer_load_dwordx4 v248, s[44:47], s11 offen sc1 lds
    ds_read_b64_tr_b16 v[180:181], v233
    ds_read_b64_tr_b16 v[182:183], v233 offset:256
    v_mfma_f32_32x32x16_bf16 v[144:159], v[212:215], v[8:11], v[144:159]
    ds_read_b128 v[204:207], v220 offset:17408
    ds_read_b64_tr_b16 v[18:19], v218 offset:8448
    s_waitcnt lgkmcnt(6)
    v_mfma_f32_32x32x16_bf16 v[128:143], v[192:195], v[12:15], v[128:143]
    ds_read_b128 v[208:211], v220 offset:18432
    ds_read_b64_tr_b16 v[20:21], v218 offset:9216
    s_add_u32 m0, s30, 0
    s_add_u32 s11, s29, 16384
    buffer_load_dwordx4 v248, s[44:47], s11 offen sc1 lds
    s_waitcnt lgkmcnt(4)
    v_dot2c_f32_bf16 v176, s76, v180
    v_dot2c_f32_bf16 v177, v180, v180
    v_dot2c_f32_bf16 v176, s76, v181
    v_dot2c_f32_bf16 v177, v181, v181
    v_dot2c_f32_bf16 v176, s76, v182
    v_dot2c_f32_bf16 v177, v182, v182
    v_dot2c_f32_bf16 v176, s76, v183
    v_dot2c_f32_bf16 v177, v183, v183
    s_nop 2
    v_permlane32_swap_b32 v176, v177
    v_add_f32 v176, v176, v177
    ds_write_b32 v234, v176
    v_mfma_f32_32x32x16_bf16 v[144:159], v[196:199], v[12:15], v[144:159]
    ds_read_b128 v[212:215], v220 offset:19456
    ds_read_b64_tr_b16 v[22:23], v218 offset:9472
    s_waitcnt lgkmcnt(5)
    v_mfma_f32_32x32x16_bf16 v[128:143], v[200:203], v[16:19], v[128:143]
    ds_read_b128 v[192:195], v220 offset:24576
    ds_read_b64_tr_b16 v[24:25], v218 offset:16384
    v_mfma_f32_32x32x16_bf16 v[144:159], v[204:207], v[16:19], v[144:159]
    ds_read_b128 v[196:199], v220 offset:25600
    ds_read_b64_tr_b16 v[26:27], v218 offset:16640
    s_waitcnt lgkmcnt(4)
    v_mfma_f32_32x32x16_bf16 v[128:143], v[208:211], v[20:23], v[128:143]
    ds_read_b128 v[200:203], v220 offset:26624
    ds_read_b64_tr_b16 v[28:29], v218 offset:17408
    v_mfma_f32_32x32x16_bf16 v[144:159], v[212:215], v[20:23], v[144:159]
    ds_read_b128 v[204:207], v220 offset:27648
    ds_read_b64_tr_b16 v[30:31], v218 offset:17664
    s_waitcnt lgkmcnt(4)
    s_waitcnt vmcnt(3)
    s_barrier
    v_mfma_f32_32x32x16_bf16 v[128:143], v[192:195], v[24:27], v[128:143]
    ds_read_b128 v[208:211], v220 offset:32768
    ds_read_b64_tr_b16 v[32:33], v218 offset:40960
    s_add_u32 m0, s30, 114688
    s_add_u32 s11, s29, 18432
    buffer_load_dwordx4 v248, s[44:47], s11 offen sc1 lds
    v_mfma_f32_32x32x16_bf16 v[144:159], v[196:199], v[24:27], v[144:159]
    ds_read_b128 v[212:215], v220 offset:33792
    ds_read_b64_tr_b16 v[34:35], v218 offset:41216
    s_waitcnt lgkmcnt(4)
    v_mfma_f32_32x32x16_bf16 v[128:143], v[200:203], v[28:31], v[128:143]
    ds_read_b128 v[192:195], v220 offset:34816
    ds_read_b64_tr_b16 v[36:37], v218 offset:41984
    s_add_u32 m0, s30, 106496
    s_add_u32 s11, s29, 20480
    buffer_load_dwordx4 v248, s[44:47], s11 offen sc1 lds
    v_mfma_f32_32x32x16_bf16 v[144:159], v[204:207], v[28:31], v[144:159]
    ds_read_b128 v[196:199], v220 offset:35840
    ds_read_b64_tr_b16 v[38:39], v218 offset:42240
    s_waitcnt lgkmcnt(4)
    v_mfma_f32_32x32x16_bf16 v[128:143], v[208:211], v[32:35], v[128:143]
    ds_read_b128 v[200:203], v220 offset:40960
    ds_read_b64_tr_b16 v[40:41], v218 offset:32768
    s_add_u32 m0, s30, 16384
    s_add_u32 s11, s29, 22528
    buffer_load_dwordx4 v248, s[44:47], s11 offen sc1 lds
    v_mfma_f32_32x32x16_bf16 v[144:159], v[212:215], v[32:35], v[144:159]
    ds_read_b128 v[204:207], v220 offset:41984
    ds_read_b64_tr_b16 v[42:43], v218 offset:33024
    s_waitcnt lgkmcnt(4)
    v_mfma_f32_32x32x16_bf16 v[128:143], v[192:195], v[36:39], v[128:143]
    ds_read_b128 v[208:211], v220 offset:43008
    ds_read_b64_tr_b16 v[44:45], v218 offset:33792
    s_add_u32 m0, s30, 8192
    s_add_u32 s11, s29, 24576
    buffer_load_dwordx4 v248, s[44:47], s11 offen sc1 lds
    v_mfma_f32_32x32x16_bf16 v[144:159], v[196:199], v[36:39], v[144:159]
    ds_read_b128 v[212:215], v220 offset:44032
    ds_read_b64_tr_b16 v[46:47], v218 offset:34048
    s_waitcnt lgkmcnt(4)
    s_waitcnt vmcnt(5)
    s_barrier
    v_mfma_f32_32x32x16_bf16 v[128:143], v[200:203], v[40:43], v[128:143]
    ds_read_b128 v[192:195], v220 offset:49152
    ds_read_b64_tr_b16 v[48:49], v218 offset:24576
    s_add_u32 m0, s30, 122880
    s_add_u32 s11, s29, 26624
    buffer_load_dwordx4 v248, s[44:47], s11 offen sc1 lds
    v_mfma_f32_32x32x16_bf16 v[144:159], v[204:207], v[40:43], v[144:159]
    ds_read_b128 v[196:199], v220 offset:50176
    ds_read_b64_tr_b16 v[50:51], v218 offset:24832
    s_waitcnt lgkmcnt(4)
    v_mfma_f32_32x32x16_bf16 v[128:143], v[208:211], v[44:47], v[128:143]
    ds_read_b128 v[200:203], v220 offset:51200
    ds_read_b64_tr_b16 v[52:53], v218 offset:25600
    s_add_u32 m0, s30, 24576
    s_add_u32 s11, s28, 98304
    buffer_load_dwordx4 v248, s[44:47], s11 offen sc1 lds
    v_mfma_f32_32x32x16_bf16 v[144:159], v[212:215], v[44:47], v[144:159]
    ds_read_b128 v[204:207], v220 offset:52224
    ds_read_b64_tr_b16 v[54:55], v218 offset:25856
    s_waitcnt lgkmcnt(4)
    v_mfma_f32_32x32x16_bf16 v[128:143], v[192:195], v[48:51], v[128:143]
    ds_read_b128 v[208:211], v221 offset:0
    ds_read_b64_tr_b16 v[56:57], v217 offset:40960
    s_add_u32 m0, s30, 32768
    s_add_u32 s11, s28, 106496
    buffer_load_dwordx4 v248, s[44:47], s11 offen sc1 lds
    v_mfma_f32_32x32x16_bf16 v[144:159], v[196:199], v[48:51], v[144:159]
    ds_read_b128 v[212:215], v221 offset:1024
    ds_read_b64_tr_b16 v[58:59], v217 offset:41216
    s_waitcnt lgkmcnt(4)
    v_mfma_f32_32x32x16_bf16 v[128:143], v[200:203], v[52:55], v[128:143]
    ds_read_b128 v[192:195], v221 offset:2048
    ds_read_b64_tr_b16 v[60:61], v217 offset:41984
    v_mfma_f32_32x32x16_bf16 v[144:159], v[204:207], v[52:55], v[144:159]
    ds_read_b128 v[196:199], v221 offset:3072
    ds_read_b64_tr_b16 v[62:63], v217 offset:42240
    s_waitcnt lgkmcnt(4)
    s_waitcnt vmcnt(6)
    s_barrier
    v_mfma_f32_32x32x16_bf16 v[128:143], v[208:211], v[56:59], v[128:143]
    ds_read_b128 v[200:203], v221 offset:8192
    ds_read_b64_tr_b16 v[64:65], v216 offset:0
    s_add_u32 m0, s30, 139264
    s_add_u32 s11, s29, 28672
    buffer_load_dwordx4 v248, s[44:47], s11 offen sc1 lds
    v_mfma_f32_32x32x16_bf16 v[144:159], v[212:215], v[56:59], v[144:159]
    ds_read_b128 v[204:207], v221 offset:9216
    ds_read_b64_tr_b16 v[66:67], v216 offset:256
    s_waitcnt lgkmcnt(4)
    v_mfma_f32_32x32x16_bf16 v[128:143], v[192:195], v[60:63], v[128:143]
    ds_read_b128 v[208:211], v221 offset:10240
    ds_read_b64_tr_b16 v[68:69], v216 offset:1024
    s_add_u32 m0, s30, 131072
    s_add_u32 s11, s29, 30720
    buffer_load_dwordx4 v248, s[44:47], s11 offen sc1 lds
    buffer_load_dword v184, v235, s[44:47], s38 offen offset:0 sc1
    v_mfma_f32_32x32x16_bf16 v[144:159], v[196:199], v[60:63], v[144:159]
    ds_read_b128 v[212:215], v221 offset:11264
    ds_read_b64_tr_b16 v[70:71], v216 offset:1280
    s_waitcnt lgkmcnt(4)
    v_mfma_f32_32x32x16_bf16 v[128:143], v[200:203], v[64:67], v[128:143]
    ds_read_b128 v[192:195], v221 offset:16384
    ds_read_b64_tr_b16 v[72:73], v218 offset:8192
    s_add_u32 m0, s30, 40960
    s_add_u32 s11, s28, 114688
    buffer_load_dwordx4 v248, s[44:47], s11 offen sc1 lds
    buffer_load_dword v185, v235, s[44:47], s38 offen offset:256 sc1
    v_mfma_f32_32x32x16_bf16 v[144:159], v[204:207], v[64:67], v[144:159]
    ds_read_b128 v[196:199], v221 offset:17408
    ds_read_b64_tr_b16 v[74:75], v218 offset:8448
    s_waitcnt lgkmcnt(4)
    v_mfma_f32_32x32x16_bf16 v[128:143], v[208:211], v[68:71], v[128:143]
    ds_read_b128 v[200:203], v221 offset:18432
    ds_read_b64_tr_b16 v[76:77], v218 offset:9216
    s_add_u32 m0, s30, 49152
    s_add_u32 s11, s28, 122880
    buffer_load_dwordx4 v248, s[44:47], s11 offen sc1 lds
    buffer_load_dword v186, v235, s[44:47], s38 offen offset:512 sc1
    v_mfma_f32_32x32x16_bf16 v[144:159], v[212:215], v[68:71], v[144:159]
    ds_read_b128 v[204:207], v221 offset:19456
    ds_read_b64_tr_b16 v[78:79], v218 offset:9472
    s_waitcnt lgkmcnt(4)
    s_waitcnt vmcnt(11)
    s_barrier
    v_mfma_f32_32x32x16_bf16 v[128:143], v[192:195], v[72:75], v[128:143]
    ds_read_b128 v[208:211], v221 offset:24576
    ds_read_b64_tr_b16 v[80:81], v218 offset:0
    s_add_u32 m0, s30, 0
    s_add_u32 s11, s28, 0
    buffer_load_dwordx4 v248, s[44:47], s11 offen sc1 lds
    buffer_load_dword v187, v235, s[44:47], s38 offen offset:768 sc1
    v_mfma_f32_32x32x16_bf16 v[144:159], v[196:199], v[72:75], v[144:159]
    ds_read_b128 v[212:215], v221 offset:25600
    ds_read_b64_tr_b16 v[82:83], v218 offset:256
    s_waitcnt lgkmcnt(4)
    v_mfma_f32_32x32x16_bf16 v[128:143], v[200:203], v[76:79], v[128:143]
    ds_read_b128 v[192:195], v221 offset:26624
    ds_read_b64_tr_b16 v[84:85], v218 offset:1024
    s_add_u32 m0, s30, 147456
    s_add_u32 s11, s32, 0
    buffer_load_dwordx4 v248, s[44:47], s11 offen sc1 lds
    v_mfma_f32_32x32x16_bf16 v[144:159], v[204:207], v[76:79], v[144:159]
    ds_read_b128 v[196:199], v221 offset:27648
    ds_read_b64_tr_b16 v[86:87], v218 offset:1280
    s_waitcnt lgkmcnt(4)
    v_mfma_f32_32x32x16_bf16 v[128:143], v[208:211], v[80:83], v[128:143]
    ds_read_b128 v[200:203], v221 offset:32768
    ds_read_b64_tr_b16 v[88:89], v216 offset:16384
    s_add_u32 m0, s30, 155648
    s_add_u32 s11, s32, 8192
    buffer_load_dwordx4 v248, s[44:47], s11 offen sc1 lds
    v_mfma_f32_32x32x16_bf16 v[144:159], v[212:215], v[80:83], v[144:159]
    ds_read_b128 v[204:207], v221 offset:33792
    ds_read_b64_tr_b16 v[90:91], v216 offset:16640
    s_waitcnt lgkmcnt(4)
    v_mfma_f32_32x32x16_bf16 v[128:143], v[192:195], v[84:87], v[128:143]
    ds_read_b128 v[208:211], v221 offset:34816
    ds_read_b64_tr_b16 v[92:93], v216 offset:17408
    s_add_u32 m0, s30, 57344
    s_add_u32 s11, s28, 8192
    buffer_load_dwordx4 v248, s[44:47], s11 offen sc1 lds
    v_mfma_f32_32x32x16_bf16 v[144:159], v[196:199], v[84:87], v[144:159]
    ds_read_b128 v[212:215], v221 offset:35840
    ds_read_b64_tr_b16 v[94:95], v216 offset:17664
    s_waitcnt lgkmcnt(4)
    s_waitcnt vmcnt(12)
    s_barrier
    v_mfma_f32_32x32x16_bf16 v[128:143], v[200:203], v[88:91], v[128:143]
    ds_read_b128 v[192:195], v220 offset:24576
    ds_read_b64_tr_b16 v[96:97], v216 offset:8192
    s_add_u32 m0, s30, 65536
    s_add_u32 s11, s28, 16384
    buffer_load_dwordx4 v248, s[44:47], s11 offen sc1 lds
    v_mfma_f32_32x32x16_bf16 v[144:159], v[204:207], v[88:91], v[144:159]
    ds_read_b128 v[196:199], v220 offset:25600
    ds_read_b64_tr_b16 v[98:99], v216 offset:8448
    s_waitcnt lgkmcnt(4)
    v_mfma_f32_32x32x16_bf16 v[128:143], v[208:211], v[92:95], v[128:143]
    ds_read_b128 v[200:203], v220 offset:26624
    ds_read_b64_tr_b16 v[100:101], v216 offset:9216
    s_add_u32 m0, s30, 73728
    s_add_u32 s11, s33, 0
    buffer_load_dwordx4 v227, s[52:55], s11 offen lds
    v_mfma_f32_32x32x16_bf16 v[144:159], v[212:215], v[92:95], v[144:159]
    ds_read_b128 v[204:207], v220 offset:27648
    ds_read_b64_tr_b16 v[102:103], v216 offset:9472
    s_waitcnt lgkmcnt(4)
    v_mfma_f32_32x32x16_bf16 v[128:143], v[192:195], v[96:99], v[128:143]
    ds_read_b128 v[208:211], v220 offset:32768
    ds_read_b64_tr_b16 v[104:105], v218 offset:16384
    s_add_u32 m0, s30, 81920
    s_add_u32 s11, s28, 24576
    buffer_load_dwordx4 v248, s[44:47], s11 offen sc1 lds
    s_waitcnt vmcnt(6)
    v_and_b32 v188, v184, v185
    v_and_b32 v189, v186, v187
    v_and_b32 v188, v188, v189
    v_and_b32 v188, 1, v188
    v_cmp_eq_u32 vcc, 0, v188
    s_nop 0
    s_cbranch_vccnz L_stwait0
L_stok0:
    v_mfma_f32_32x32x16_bf16 v[144:159], v[196:199], v[96:99], v[144:159]
    ds_read_b128 v[212:215], v220 offset:33792
    ds_read_b64_tr_b16 v[106:107], v218 offset:16640
    v_add_f32 v184, v184, v185
    v_add_f32 v186, v186, v187
    v_add_f32 v184, v184, v186
    s_waitcnt lgkmcnt(4)
    v_mfma_f32_32x32x16_bf16 v[128:143], v[200:203], v[100:103], v[128:143]
    ds_read_b128 v[192:195], v220 offset:34816
    ds_read_b64_tr_b16 v[108:109], v218 offset:17408
    s_add_u32 m0, s30, 98304
    s_add_u32 s11, s33, 16384
    buffer_load_dwordx4 v227, s[52:55], s11 offen lds
    v_mov_b32 v185, v184
    v_mfma_f32_32x32x16_bf16 v[144:159], v[204:207], v[100:103], v[144:159]
    ds_read_b128 v[196:199], v220 offset:35840
    ds_read_b64_tr_b16 v[110:111], v218 offset:17664
    v_permlane32_swap_b32 v184, v185
    v_mul_f32 v236, 0x3b000000, v184
    v_mul_f32 v186, v236, v236
    s_waitcnt lgkmcnt(4)
    s_barrier
    v_mfma_f32_32x32x16_bf16 v[128:143], v[208:211], v[104:107], v[128:143]
    ds_read_b128 v[200:203], v220 offset:40960
    ds_read_b64_tr_b16 v[112:113], v218 offset:32768
    s_add_u32 m0, s30, 8192
    s_add_u32 s11, s28, 32768
    buffer_load_dwordx4 v248, s[44:47], s11 offen sc1 lds
    v_mul_f32 v237, 0x3b000000, v185
    v_sub_f32 v237, v237, v186
    v_max_f32 v237, 0, v237
    v_cvt_pk_bf16_f32 v186, v236, v237
    v_lshlrev_b32 v236, 16, v186
    v_and_b32 v237, 0xffff0000, v186
    v_mfma_f32_32x32x16_bf16 v[144:159], v[212:215], v[104:107], v[144:159]
    ds_read_b128 v[204:207], v220 offset:41984
    ds_read_b64_tr_b16 v[114:115], v218 offset:33024
    v_add_f32 v237, 0x3727c5ac, v237
    v_cvt_pk_bf16_f32 v186, v237, v237
    v_lshlrev_b32 v237, 16, v186
    s_waitcnt lgkmcnt(4)
    v_mfma_f32_32x32x16_bf16 v[128:143], v[192:195], v[108:111], v[128:143]
    ds_read_b128 v[208:211], v220 offset:43008
    ds_read_b64_tr_b16 v[116:117], v218 offset:33792
    s_add_u32 m0, s30, 16384
    s_add_u32 s11, s33, 32768
    buffer_load_dwordx4 v227, s[52:55], s11 offen lds
    v_sqrt_f32 v237, v237
    s_nop 0
    v_cvt_pk_bf16_f32 v186, v237, v237
    v_lshlrev_b32 v237, 16, v186
    v_xor_b32 v236, 0x80000000, v236
    v_lshrrev_b32 v240, 16, v236
    v_mfma_f32_32x32x16_bf16 v[144:159], v[196:199], v[108:111], v[144:159]
    ds_read_b128 v[212:215], v220 offset:44032
    ds_read_b64_tr_b16 v[118:119], v218 offset:34048
    v_or_b32 v240, v240, v236
    v_mov_b32 v241, v240
    v_mov_b32 v242, v240
    s_waitcnt lgkmcnt(4)
    v_mfma_f32_32x32x16_bf16 v[128:143], v[200:203], v[112:115], v[128:143]
    ds_read_b128 v[192:195], v220 offset:49152
    ds_read_b64_tr_b16 v[120:121], v218 offset:24576
    s_add_u32 m0, s30, 24576
    s_add_u32 s11, s28, 40960
    buffer_load_dwordx4 v248, s[44:47], s11 offen sc1 lds
    v_mov_b32 v243, v240
    v_rcp_f32 v236, v237
    v_mul_f32 v237, v237, v237
    v_mul_f32 v236, 0xbfb8aa3b, v236
    v_mfma_f32_32x32x16_bf16 v[144:159], v[204:207], v[112:115], v[144:159]
    ds_read_b128 v[196:199], v220 offset:50176
    ds_read_b64_tr_b16 v[122:123], v218 offset:24832
    s_waitcnt lgkmcnt(4)
    v_mfma_f32_32x32x16_bf16 v[128:143], v[208:211], v[116:119], v[128:143]
    ds_read_b128 v[200:203], v220 offset:51200
    ds_read_b64_tr_b16 v[124:125], v218 offset:25600
    s_add_u32 m0, s30, 90112
    s_add_u32 s11, s33, 49152
    buffer_load_dwordx4 v227, s[52:55], s11 offen lds
    v_mfma_f32_32x32x16_bf16 v[144:159], v[212:215], v[116:119], v[144:159]
    ds_read_b128 v[204:207], v220 offset:52224
    ds_read_b64_tr_b16 v[126:127], v218 offset:25856
    s_waitcnt lgkmcnt(4)
    s_waitcnt vmcnt(9)
    s_barrier
    v_mfma_f32_32x32x16_bf16 v[128:143], v[192:195], v[120:123], v[128:143]
    ds_read_b128 v[208:211], v220 offset:0
    s_add_u32 m0, s30, 32768
    s_add_u32 s11, s28, 49152
    buffer_load_dwordx4 v248, s[44:47], s11 offen sc1 lds
    v_mfma_f32_32x32x16_bf16 v[144:159], v[196:199], v[120:123], v[144:159]
    ds_read_b64_tr_b16 v[212:213], v229 offset:0
    ds_read_b64_tr_b16 v[214:215], v229 offset:3584
    s_waitcnt lgkmcnt(3)
    v_mfma_f32_32x32x16_bf16 v[128:143], v[200:203], v[124:127], v[128:143]
    ds_read_b64_tr_b16 v[192:193], v229 offset:448
    ds_read_b64_tr_b16 v[194:195], v229 offset:4032
    s_add_u32 m0, s30, 40960
    s_add_u32 s11, s33, 65536
    buffer_load_dwordx4 v227, s[52:55], s11 offen lds
    v_mfma_f32_32x32x16_bf16 v[144:159], v[204:207], v[124:127], v[144:159]
    ds_read_b64_tr_b16 v[196:197], v229 offset:64
    ds_read_b64_tr_b16 v[198:199], v229 offset:3648
    s_waitcnt lgkmcnt(6)
    v_mfma_f32_32x32x16_bf16 v[160:175], v[208:211], v[0:3], 0
    ds_read_b64_tr_b16 v[200:201], v229 offset:512
    ds_read_b64_tr_b16 v[202:203], v229 offset:4096
    s_add_u32 m0, s30, 106496
    s_add_u32 s11, s28, 57344
    buffer_load_dwordx4 v248, s[44:47], s11 offen sc1 lds
    s_waitcnt lgkmcnt(6)
    v_mfma_f32_32x32x16_bf16 v[128:143], v[212:215], v[240:243], v[128:143]
    ds_read_b64_tr_b16 v[204:205], v229 offset:256
    ds_read_b64_tr_b16 v[206:207], v229 offset:3840
    s_waitcnt lgkmcnt(6)
    v_mfma_f32_32x32x16_bf16 v[128:143], v[192:195], v[240:243], v[128:143]
    ds_read_b64_tr_b16 v[208:209], v229 offset:704
    ds_read_b64_tr_b16 v[210:211], v229 offset:4288
    s_add_u32 m0, s30, 114688
    s_add_u32 s11, s33, 81920
    buffer_load_dwordx4 v227, s[52:55], s11 offen lds
    s_waitcnt lgkmcnt(6)
    v_mfma_f32_32x32x16_bf16 v[144:159], v[196:199], v[240:243], v[144:159]
    ds_read_b64_tr_b16 v[212:213], v229 offset:384
    ds_read_b64_tr_b16 v[214:215], v229 offset:3968
    s_waitcnt lgkmcnt(6)
    v_mfma_f32_32x32x16_bf16 v[144:159], v[200:203], v[240:243], v[144:159]
    ds_read_b128 v[192:195], v220 offset:2048
    s_waitcnt lgkmcnt(5)
    v_mfma_f32_32x32x16_bf16 v[160:175], v[204:207], v[240:243], v[160:175]
    ds_read_b128 v[196:199], v220 offset:4096
    v_mul_f32 v216, v236, v128
    v_mul_f32 v217, v236, v129
    v_mul_f32 v218, v236, v130
    v_mul_f32 v219, v236, v131
    v_exp_f32 v216, v216
    v_exp_f32 v217, v217
    s_waitcnt lgkmcnt(4)
    s_waitcnt vmcnt(8)
    s_barrier
    v_mfma_f32_32x32x16_bf16 v[160:175], v[208:211], v[240:243], v[160:175]
    ds_read_b128 v[200:203], v220 offset:6144
    s_add_u32 m0, s30, 49152
    s_add_u32 s11, s28, 65536
    buffer_load_dwordx4 v248, s[44:47], s11 offen sc1 lds
    v_exp_f32 v218, v218
    v_exp_f32 v219, v219
    v_mul_f32 v128, v128, v136
    v_mul_f32 v129, v129, v137
    s_waitcnt lgkmcnt(3)
    v_mfma_f32_32x32x16_bf16 v[176:191], v[212:215], v[240:243], 0
    ds_read_b128 v[204:207], v221 offset:0
    v_mul_f32 v130, v130, v138
    v_mul_f32 v131, v131, v139
    v_fma_f32 v216, v216, v237, v237
    v_fma_f32 v217, v217, v237, v237
    v_fma_f32 v218, v218, v237, v237
    v_fma_f32 v219, v219, v237, v237
    v_rcp_f32 v216, v216
    s_waitcnt lgkmcnt(3)
    v_mfma_f32_32x32x16_bf16 v[160:175], v[192:195], v[4:7], v[160:175]
    ds_read_b128 v[208:211], v221 offset:2048
    s_add_u32 m0, s30, 122880
    s_add_u32 s11, s33, 98304
    buffer_load_dwordx4 v227, s[52:55], s11 offen lds
    v_rcp_f32 v217, v217
    v_rcp_f32 v218, v218
    v_rcp_f32 v219, v219
    s_waitcnt lgkmcnt(3)
    v_mfma_f32_32x32x16_bf16 v[160:175], v[196:199], v[8:11], v[160:175]
    ds_read_b128 v[212:215], v221 offset:4096
    v_mul_f32 v128, v128, v216
    v_mul_f32 v129, v129, v217
    v_mul_f32 v130, v130, v218
    v_mul_f32 v131, v131, v219
    v_cvt_pk_bf16_f32 v244, v128, v129
    v_cvt_pk_bf16_f32 v245, v130, v131
    v_mul_f32 v216, v236, v132
    v_mul_f32 v217, v236, v133
    s_waitcnt lgkmcnt(3)
    v_mfma_f32_32x32x16_bf16 v[160:175], v[200:203], v[12:15], v[160:175]
    ds_read_b128 v[192:195], v221 offset:6144
    s_add_u32 m0, s30, 131072
    s_add_u32 s11, s28, 73728
    buffer_load_dwordx4 v248, s[44:47], s11 offen sc1 lds
    v_mul_f32 v218, v236, v134
    v_mul_f32 v219, v236, v135
    v_exp_f32 v216, v216
    v_exp_f32 v217, v217
    s_waitcnt lgkmcnt(3)
    v_mfma_f32_32x32x16_bf16 v[160:175], v[204:207], v[16:19], v[160:175]
    ds_read_b128 v[196:199], v221 offset:8192
    ds_read_b64_tr_b16 v[4:5], v223 offset:16384
    v_exp_f32 v218, v218
    v_exp_f32 v219, v219
    v_mul_f32 v132, v132, v140
    v_mul_f32 v133, v133, v141
    v_mul_f32 v134, v134, v142
    v_mul_f32 v135, v135, v143
    s_waitcnt lgkmcnt(4)
    v_mfma_f32_32x32x16_bf16 v[160:175], v[208:211], v[20:23], v[160:175]
    ds_read_b128 v[200:203], v221 offset:10240
    ds_read_b64_tr_b16 v[6:7], v223 offset:17408
    s_add_u32 m0, s30, 139264
    s_add_u32 s11, s33, 114688
    buffer_load_dwordx4 v227, s[52:55], s11 offen lds
    v_fma_f32 v216, v216, v237, v237
    v_fma_f32 v217, v217, v237, v237
    v_fma_f32 v218, v218, v237, v237
    v_fma_f32 v219, v219, v237, v237
    v_rcp_f32 v216, v216
    s_waitcnt lgkmcnt(5)
    v_mfma_f32_32x32x16_bf16 v[160:175], v[212:215], v[24:27], v[160:175]
    ds_read_b128 v[204:207], v221 offset:12288
    ds_read_b64_tr_b16 v[12:13], v225 offset:16384
    v_rcp_f32 v217, v217
    v_rcp_f32 v218, v218
    v_rcp_f32 v219, v219
    v_mul_f32 v132, v132, v216
    v_mul_f32 v133, v133, v217
    s_waitcnt lgkmcnt(6)
    v_mfma_f32_32x32x16_bf16 v[160:175], v[192:195], v[28:31], v[160:175]
    ds_read_b128 v[208:211], v221 offset:14336
    ds_read_b64_tr_b16 v[14:15], v225 offset:17408
    v_mul_f32 v134, v134, v218
    v_mul_f32 v135, v135, v219
    v_cvt_pk_bf16_f32 v246, v132, v133
    v_cvt_pk_bf16_f32 v247, v134, v135
    buffer_store_dwordx4 v[244:247], v248, s[44:47], s31 offen offset:0 sc1
    v_mul_f32 v216, v236, v144
    v_mul_f32 v217, v236, v145
    v_mul_f32 v218, v236, v146
    s_waitcnt lgkmcnt(7)
    v_mfma_f32_32x32x16_bf16 v[160:175], v[196:199], v[32:35], v[160:175]
    ds_read_b128 v[212:215], v221 offset:24576
    ds_read_b64_tr_b16 v[20:21], v223 offset:40960
    v_mul_f32 v219, v236, v147
    v_exp_f32 v216, v216
    v_exp_f32 v217, v217
    v_exp_f32 v218, v218
    v_exp_f32 v219, v219
    s_waitcnt lgkmcnt(7)
    s_waitcnt vmcnt(9)
    s_barrier
    v_mfma_f32_32x32x16_bf16 v[160:175], v[200:203], v[36:39], v[160:175]
    ds_read_b128 v[192:195], v221 offset:26624
    ds_read_b64_tr_b16 v[22:23], v223 offset:41984
    s_add_u32 m0, s30, 57344
    s_add_u32 s11, s28, 81920
    buffer_load_dwordx4 v248, s[44:47], s11 offen sc1 lds
    v_mul_f32 v144, v144, v152
    v_mul_f32 v145, v145, v153
    v_mul_f32 v146, v146, v154
    v_mul_f32 v147, v147, v155
    v_fma_f32 v216, v216, v237, v237
    s_waitcnt lgkmcnt(7)
    v_mfma_f32_32x32x16_bf16 v[160:175], v[204:207], v[40:43], v[160:175]
    ds_read_b128 v[196:199], v221 offset:28672
    ds_read_b64_tr_b16 v[28:29], v225 offset:40960
    v_fma_f32 v217, v217, v237, v237
    v_fma_f32 v218, v218, v237, v237
    v_fma_f32 v219, v219, v237, v237
    v_rcp_f32 v216, v216
    v_rcp_f32 v217, v217
    v_rcp_f32 v218, v218
    s_waitcnt lgkmcnt(7)
    v_mfma_f32_32x32x16_bf16 v[160:175], v[208:211], v[44:47], v[160:175]
    ds_read_b128 v[200:203], v221 offset:30720
    ds_read_b64_tr_b16 v[30:31], v225 offset:41984
    s_add_u32 m0, s30, 147456
    s_add_u32 s11, s28, 90112
    buffer_load_dwordx4 v248, s[44:47], s11 offen sc1 lds
    v_rcp_f32 v219, v219
    v_mul_f32 v144, v144, v216
    v_mul_f32 v145, v145, v217
    v_mul_f32 v146, v146, v218
    s_waitcnt lgkmcnt(7)
    v_mfma_f32_32x32x16_bf16 v[160:175], v[212:215], v[48:51], v[160:175]
    ds_read_b128 v[204:207], v220 offset:8192
    ds_read_b64_tr_b16 v[36:37], v254 offset:16384
    v_mul_f32 v147, v147, v219
    v_cvt_pk_bf16_f32 v136, v144, v145
    v_cvt_pk_bf16_f32 v137, v146, v147
    v_mul_f32 v216, v236, v148
    v_mul_f32 v217, v236, v149
    v_mul_f32 v218, v236, v150
    v_mul_f32 v219, v236, v151
    v_exp_f32 v216, v216
    s_waitcnt lgkmcnt(7)
    v_mfma_f32_32x32x16_bf16 v[160:175], v[192:195], v[52:55], v[160:175]
    ds_read_b128 v[208:211], v220 offset:10240
    ds_read_b64_tr_b16 v[38:39], v254 offset:17408
    s_add_u32 m0, s30, 155648
    s_nop 0
    buffer_load_dwordx4 v248, s[44:47], s75 offen sc1 lds
    v_exp_f32 v217, v217
    v_exp_f32 v218, v218
    v_exp_f32 v219, v219
    s_waitcnt lgkmcnt(7)
    v_mfma_f32_32x32x16_bf16 v[160:175], v[196:199], v[56:59], v[160:175]
    ds_read_b128 v[212:215], v220 offset:12288
    ds_read_b64_tr_b16 v[44:45], v255 offset:16384
    v_mul_f32 v148, v148, v156
    v_mul_f32 v149, v149, v157
    v_mul_f32 v150, v150, v158
    v_mul_f32 v151, v151, v159
    v_fma_f32 v216, v216, v237, v237
    v_fma_f32 v217, v217, v237, v237
    v_fma_f32 v218, v218, v237, v237
    s_waitcnt lgkmcnt(7)
    v_mfma_f32_32x32x16_bf16 v[160:175], v[200:203], v[60:63], v[160:175]
    ds_read_b128 v[192:195], v220 offset:14336
    ds_read_b64_tr_b16 v[46:47], v255 offset:17408
    v_fma_f32 v219, v219, v237, v237
    v_rcp_f32 v216, v216
    v_rcp_f32 v217, v217
    v_rcp_f32 v218, v218
    v_rcp_f32 v219, v219
    s_waitcnt lgkmcnt(7)
    v_mfma_f32_32x32x16_bf16 v[160:175], v[204:207], v[64:67], v[160:175]
    ds_read_b128 v[196:199], v220 offset:24576
    ds_read_b64_tr_b16 v[52:53], v223 offset:32768
    v_mul_f32 v148, v148, v216
    v_mul_f32 v149, v149, v217
    v_mul_f32 v150, v150, v218
    v_mul_f32 v151, v151, v219
    v_cvt_pk_bf16_f32 v138, v148, v149
    v_cvt_pk_bf16_f32 v139, v150, v151
    buffer_store_dwordx4 v[136:139], v248, s[44:47], s31 offen offset:1024 sc1
    s_waitcnt lgkmcnt(7)
    v_mfma_f32_32x32x16_bf16 v[160:175], v[208:211], v[68:71], v[160:175]
    ds_read_b128 v[200:203], v220 offset:26624
    ds_read_b64_tr_b16 v[54:55], v223 offset:33792
    s_waitcnt lgkmcnt(7)
    v_mfma_f32_32x32x16_bf16 v[160:175], v[212:215], v[72:75], v[160:175]
    ds_read_b128 v[204:207], v220 offset:28672
    ds_read_b64_tr_b16 v[60:61], v225 offset:32768
    s_waitcnt lgkmcnt(7)
    s_waitcnt vmcnt(5)
    s_barrier
    v_mfma_f32_32x32x16_bf16 v[160:175], v[192:195], v[76:79], v[160:175]
    ds_read_b128 v[208:211], v220 offset:30720
    ds_read_b64_tr_b16 v[62:63], v225 offset:33792
    s_add_u32 m0, s30, 65536
    s_add_u32 s11, s33, 131072
    buffer_load_dwordx4 v227, s[52:55], s11 offen lds
    s_waitcnt lgkmcnt(7)
    v_mfma_f32_32x32x16_bf16 v[160:175], v[196:199], v[80:83], v[160:175]
    ds_read_b128 v[212:215], v220 offset:32768
    ds_read_b64_tr_b16 v[68:69], v254 offset:40960
    s_waitcnt lgkmcnt(7)
    v_mfma_f32_32x32x16_bf16 v[160:175], v[200:203], v[84:87], v[160:175]
    ds_read_b128 v[192:195], v220 offset:34816
    ds_read_b64_tr_b16 v[70:71], v254 offset:41984
    s_add_u32 m0, s30, 73728
    s_add_u32 s11, s33, 147456
    buffer_load_dwordx4 v227, s[52:55], s11 offen lds
    s_waitcnt lgkmcnt(7)
    v_mfma_f32_32x32x16_bf16 v[160:175], v[204:207], v[88:91], v[160:175]
    ds_read_b128 v[196:199], v220 offset:36864
    ds_read_b64_tr_b16 v[76:77], v255 offset:40960
    s_waitcnt lgkmcnt(7)
    v_mfma_f32_32x32x16_bf16 v[160:175], v[208:211], v[92:95], v[160:175]
    ds_read_b128 v[200:203], v220 offset:38912
    ds_read_b64_tr_b16 v[78:79], v255 offset:41984
    s_add_u32 m0, s30, 81920
    s_add_u32 s11, s33, 163840
    buffer_load_dwordx4 v227, s[52:55], s11 offen lds
    s_waitcnt lgkmcnt(7)
    v_mfma_f32_32x32x16_bf16 v[160:175], v[212:215], v[96:99], v[160:175]
    ds_read_b128 v[204:207], v222 offset:0
    ds_read_b64_tr_b16 v[84:85], v224 offset:8192
    s_waitcnt lgkmcnt(7)
    v_mfma_f32_32x32x16_bf16 v[160:175], v[192:195], v[100:103], v[160:175]
    ds_read_b128 v[208:211], v222 offset:2048
    ds_read_b64_tr_b16 v[86:87], v224 offset:9216
    s_add_u32 m0, s30, 98304
    s_add_u32 s11, s33, 180224
    buffer_load_dwordx4 v227, s[52:55], s11 offen lds
    s_waitcnt lgkmcnt(7)
    v_mfma_f32_32x32x16_bf16 v[160:175], v[196:199], v[104:107], v[160:175]
    ds_read_b128 v[212:215], v222 offset:4096
    ds_read_b64_tr_b16 v[92:93], v226 offset:8192
    s_waitcnt lgkmcnt(7)
    v_mfma_f32_32x32x16_bf16 v[160:175], v[200:203], v[108:111], v[160:175]
    ds_read_b128 v[192:195], v222 offset:6144
    ds_read_b64_tr_b16 v[94:95], v226 offset:9216
    s_waitcnt lgkmcnt(7)
    v_mfma_f32_32x32x16_bf16 v[160:175], v[204:207], v[112:115], v[160:175]
    ds_read_b128 v[196:199], v220 offset:49152
    ds_read_b64_tr_b16 v[100:101], v224 offset:16384
    s_waitcnt lgkmcnt(7)
    v_mfma_f32_32x32x16_bf16 v[160:175], v[208:211], v[116:119], v[160:175]
    ds_read_b128 v[200:203], v220 offset:51200
    ds_read_b64_tr_b16 v[102:103], v224 offset:17408
    s_waitcnt lgkmcnt(7)
    v_mfma_f32_32x32x16_bf16 v[160:175], v[212:215], v[120:123], v[160:175]
    ds_read_b128 v[204:207], v220 offset:53248
    ds_read_b64_tr_b16 v[108:109], v226 offset:16384
    s_waitcnt lgkmcnt(7)
    v_mfma_f32_32x32x16_bf16 v[160:175], v[192:195], v[124:127], v[160:175]
    ds_read_b128 v[208:211], v220 offset:55296
    ds_read_b64_tr_b16 v[110:111], v226 offset:17408
    s_waitcnt lgkmcnt(7)
    v_mfma_f32_32x32x16_bf16 v[176:191], v[196:199], v[0:3], v[176:191]
    ds_read_b128 v[212:215], v222 offset:24576
    ds_read_b64_tr_b16 v[116:117], v224 offset:32768
    s_waitcnt lgkmcnt(7)
    s_waitcnt vmcnt(4)
    s_barrier
    v_mfma_f32_32x32x16_bf16 v[176:191], v[200:203], v[8:11], v[176:191]
    ds_read_b128 v[192:195], v222 offset:26624
    ds_read_b64_tr_b16 v[118:119], v224 offset:33792
    s_add_u32 m0, s30, 16384
    s_add_u32 s11, s33, 196608
    buffer_load_dwordx4 v227, s[52:55], s11 offen lds
    s_waitcnt lgkmcnt(7)
    v_mfma_f32_32x32x16_bf16 v[176:191], v[204:207], v[16:19], v[176:191]
    ds_read_b128 v[196:199], v222 offset:28672
    ds_read_b64_tr_b16 v[124:125], v226 offset:32768
    v_mul_f32 v216, v236, v160
    v_mul_f32 v217, v236, v161
    v_mul_f32 v218, v236, v162
    v_mul_f32 v219, v236, v163
    v_exp_f32 v216, v216
    v_exp_f32 v217, v217
    s_waitcnt lgkmcnt(7)
    v_mfma_f32_32x32x16_bf16 v[176:191], v[208:211], v[24:27], v[176:191]
    ds_read_b128 v[200:203], v222 offset:30720
    ds_read_b64_tr_b16 v[126:127], v226 offset:33792
    s_add_u32 m0, s30, 24576
    s_add_u32 s11, s33, 212992
    buffer_load_dwordx4 v227, s[52:55], s11 offen lds
    v_exp_f32 v218, v218
    v_exp_f32 v219, v219
    v_mul_f32 v160, v160, v168
    s_waitcnt lgkmcnt(7)
    v_mfma_f32_32x32x16_bf16 v[176:191], v[212:215], v[32:35], v[176:191]
    ds_read_b128 v[204:207], v221 offset:0
    v_mul_f32 v161, v161, v169
    v_mul_f32 v162, v162, v170
    v_mul_f32 v163, v163, v171
    v_fma_f32 v216, v216, v237, v237
    v_fma_f32 v217, v217, v237, v237
    v_fma_f32 v218, v218, v237, v237
    v_fma_f32 v219, v219, v237, v237
    s_waitcnt lgkmcnt(6)
    v_mfma_f32_32x32x16_bf16 v[176:191], v[192:195], v[40:43], v[176:191]
    ds_read_b128 v[208:211], v221 offset:2048
    s_add_u32 m0, s30, 32768
    s_add_u32 s11, s33, 229376
    buffer_load_dwordx4 v227, s[52:55], s11 offen lds
    v_rcp_f32 v216, v216
    v_rcp_f32 v217, v217
    v_rcp_f32 v218, v218
    s_waitcnt lgkmcnt(5)
    v_mfma_f32_32x32x16_bf16 v[176:191], v[196:199], v[48:51], v[176:191]
    ds_read_b128 v[212:215], v221 offset:4096
    v_rcp_f32 v219, v219
    v_mul_f32 v160, v160, v216
    v_mul_f32 v161, v161, v217
    v_mul_f32 v162, v162, v218
    v_mul_f32 v163, v163, v219
    v_cvt_pk_bf16_f32 v244, v160, v161
    s_waitcnt lgkmcnt(4)
    v_mfma_f32_32x32x16_bf16 v[176:191], v[200:203], v[56:59], v[176:191]
    ds_read_b128 v[192:195], v221 offset:6144
    s_add_u32 m0, s30, 40960
    s_add_u32 s11, s33, 245760
    buffer_load_dwordx4 v227, s[52:55], s11 offen lds
    v_cvt_pk_bf16_f32 v245, v162, v163
    v_mul_f32 v216, v236, v164
    v_mul_f32 v217, v236, v165
    v_mul_f32 v218, v236, v166
    v_mul_f32 v219, v236, v167
    v_exp_f32 v216, v216
    s_waitcnt lgkmcnt(3)
    v_mfma_f32_32x32x16_bf16 v[176:191], v[204:207], v[64:67], v[176:191]
    ds_read_b128 v[196:199], v222 offset:40960
    v_exp_f32 v217, v217
    v_exp_f32 v218, v218
    v_exp_f32 v219, v219
    s_waitcnt lgkmcnt(3)
    s_barrier
    v_mfma_f32_32x32x16_bf16 v[176:191], v[208:211], v[72:75], v[176:191]
    ds_read_b128 v[200:203], v222 offset:43008
    s_add_u32 m0, s30, 49152
    s_add_u32 s11, s34, 262144
    buffer_load_dwordx4 v227, s[52:55], s11 offen lds
    v_mul_f32 v164, v164, v172
    v_mul_f32 v165, v165, v173
    v_mul_f32 v166, v166, v174
    v_mul_f32 v167, v167, v175
    v_fma_f32 v216, v216, v237, v237
    v_fma_f32 v217, v217, v237, v237
    s_waitcnt lgkmcnt(3)
    v_mfma_f32_32x32x16_bf16 v[176:191], v[212:215], v[80:83], v[176:191]
    ds_read_b128 v[204:207], v222 offset:45056
    v_fma_f32 v218, v218, v237, v237
    v_fma_f32 v219, v219, v237, v237
    v_rcp_f32 v216, v216
    v_rcp_f32 v217, v217
    v_rcp_f32 v218, v218
    s_waitcnt lgkmcnt(3)
    v_mfma_f32_32x32x16_bf16 v[176:191], v[192:195], v[88:91], v[176:191]
    ds_read_b128 v[208:211], v222 offset:47104
    s_add_u32 m0, s30, 90112
    s_add_u32 s11, s34, 278528
    buffer_load_dwordx4 v227, s[52:55], s11 offen lds
    v_rcp_f32 v219, v219
    v_mul_f32 v164, v164, v216
    v_mul_f32 v165, v165, v217
    v_mul_f32 v166, v166, v218
    s_waitcnt lgkmcnt(3)
    v_mfma_f32_32x32x16_bf16 v[176:191], v[196:199], v[96:99], v[176:191]
    v_mul_f32 v167, v167, v219
    v_cvt_pk_bf16_f32 v246, v164, v165
    v_cvt_pk_bf16_f32 v247, v166, v167
    buffer_store_dwordx4 v[244:247], v248, s[44:47], s82 offen sc1
    s_waitcnt lgkmcnt(2)
    v_mfma_f32_32x32x16_bf16 v[176:191], v[200:203], v[104:107], v[176:191]
    s_add_u32 m0, s30, 106496
    s_add_u32 s11, s34, 294912
    buffer_load_dwordx4 v227, s[52:55], s11 offen lds
    s_waitcnt lgkmcnt(1)
    v_mfma_f32_32x32x16_bf16 v[176:191], v[204:207], v[112:115], v[176:191]
    s_waitcnt lgkmcnt(0)
    v_mfma_f32_32x32x16_bf16 v[176:191], v[208:211], v[120:123], v[176:191]
    s_add_u32 m0, s30, 114688
    s_add_u32 s11, s34, 311296
    buffer_load_dwordx4 v227, s[52:55], s11 offen lds
    s_add_u32 s11, s17, 4096
    s_mov_b64 exec, 1
    buffer_load_dword v250, v252, s[44:47], s11 offen sc1
    s_mov_b64 exec, -1
    s_nop 4
    ds_write_b128 v238, v[180:183]
    ds_write_b128 v238, v[188:191] offset:1024
    s_waitcnt lgkmcnt(0)
    s_barrier
    ds_read_b128 v[180:183], v239
    ds_read_b128 v[188:191], v239 offset:1024
    s_waitcnt lgkmcnt(1)
    v_add_f32 v176, v176, v180
    v_add_f32 v177, v177, v181
    v_add_f32 v178, v178, v182
    v_add_f32 v179, v179, v183
    v_mul_f32 v216, v236, v176
    v_mul_f32 v217, v236, v177
    v_mul_f32 v218, v236, v178
    v_mul_f32 v219, v236, v179
    v_exp_f32 v216, v216
    v_exp_f32 v217, v217
    v_exp_f32 v218, v218
    v_exp_f32 v219, v219
    s_waitcnt lgkmcnt(0)
    v_add_f32 v184, v184, v188
    v_add_f32 v185, v185, v189
    v_add_f32 v186, v186, v190
    v_add_f32 v187, v187, v191
    v_fma_f32 v216, v216, v237, v237
    v_fma_f32 v217, v217, v237, v237
    v_fma_f32 v218, v218, v237, v237
    v_fma_f32 v219, v219, v237, v237
    v_rcp_f32 v216, v216
    v_rcp_f32 v217, v217
    v_rcp_f32 v218, v218
    v_rcp_f32 v219, v219
    v_mul_f32 v176, v176, v184
    v_mul_f32 v177, v177, v185
    v_mul_f32 v178, v178, v186
    v_mul_f32 v179, v179, v187
    v_mul_f32 v176, v176, v216
    v_mul_f32 v177, v177, v217
    v_mul_f32 v178, v178, v218
    v_mul_f32 v179, v179, v219
    v_cvt_pk_bf16_f32 v240, v176, v177
    v_cvt_pk_bf16_f32 v241, v178, v179
    s_nop 0
    v_permlane32_swap_b32 v240, v242
    v_permlane32_swap_b32 v241, v243
    s_mov_b32 exec_hi, 0
    buffer_store_dwordx4 v[240:243], v248, s[44:47], s79 offen sc1
    s_mov_b32 exec_hi, -1
    s_branch L_g1_join
L_g1_p1:
    s_waitcnt lgkmcnt(0)
    s_barrier
    s_add_u32 m0, s30, 98304
    s_add_u32 s11, s29, 0
    buffer_load_dwordx4 v248, s[44:47], s11 offen sc1 lds
    s_add_u32 m0, s30, 106496
    s_add_u32 s11, s29, 2048
    buffer_load_dwordx4 v248, s[44:47], s11 offen sc1 lds
    s_barrier
    s_add_u32 m0, s30, 114688
    s_add_u32 s11, s29, 4096
    buffer_load_dwordx4 v248, s[44:47], s11 offen sc1 lds
    s_add_u32 m0, s30, 122880
    s_add_u32 s11, s29, 6144
    buffer_load_dwordx4 v248, s[44:47], s11 offen sc1 lds
    s_mov_b32 m0, s39
    s_nop 0
    buffer_load_dwordx4 v248, s[44:47], s36 offen sc1 lds
    ds_read_b128 v[192:195], v220 offset:4096
    ds_read_b128 v[196:199], v220 offset:5120
    ds_read_b128 v[200:203], v220 offset:6144
    ds_read_b128 v[204:207], v220 offset:7168
    s_waitcnt vmcnt(4)
    s_barrier
    ds_read_b64_tr_b16 v[4:5], v217 offset:40960
    ds_read_b64_tr_b16 v[6:7], v217 offset:41216
    ds_read_b64_tr_b16 v[0:1], v217 offset:41984
    ds_read_b64_tr_b16 v[2:3], v217 offset:42240
    s_waitcnt lgkmcnt(2)
    s_waitcnt vmcnt(3)
    s_barrier
    v_mfma_f32_32x32x16_bf16 v[128:143], v[192:195], v[4:7], 0
    ds_read_b128 v[208:211], v220 offset:12288
    ds_read_b64_tr_b16 v[12:13], v218 offset:0
    v_mfma_f32_32x32x16_bf16 v[144:159], v[196:199], v[4:7], 0
    ds_read_b128 v[212:215], v220 offset:13312
    ds_read_b64_tr_b16 v[14:15], v218 offset:256
    s_add_u32 m0, s30, 147456
    s_add_u32 s11, s29, 8192
    buffer_load_dwordx4 v248, s[44:47], s11 offen sc1 lds
    s_waitcnt lgkmcnt(4)
    v_mfma_f32_32x32x16_bf16 v[128:143], v[200:203], v[0:3], v[128:143]
    ds_read_b128 v[192:195], v220 offset:14336
    ds_read_b64_tr_b16 v[8:9], v218 offset:1024
    s_add_u32 m0, s30, 139264
    s_add_u32 s11, s29, 10240
    buffer_load_dwordx4 v248, s[44:47], s11 offen sc1 lds
    v_mfma_f32_32x32x16_bf16 v[144:159], v[204:207], v[0:3], v[144:159]
    ds_read_b128 v[196:199], v220 offset:15360
    ds_read_b64_tr_b16 v[10:11], v218 offset:1280
    s_add_u32 m0, s30, 131072
    s_add_u32 s11, s29, 12288
    buffer_load_dwordx4 v248, s[44:47], s11 offen sc1 lds
    s_waitcnt lgkmcnt(4)
    s_waitcnt vmcnt(4)
    s_barrier
    s_waitcnt vmcnt(3)
    v_mfma_f32_32x32x16_bf16 v[128:143], v[208:211], v[12:15], v[128:143]
    ds_read_b128 v[200:203], v220 offset:20480
    ds_read_b64_tr_b16 v[20:21], v218 offset:8192
    ds_read_b64_tr_b16 v[180:181], v233
    ds_read_b64_tr_b16 v[182:183], v233 offset:256
    v_mfma_f32_32x32x16_bf16 v[144:159], v[212:215], v[12:15], v[144:159]
    ds_read_b128 v[204:207], v220 offset:21504
    ds_read_b64_tr_b16 v[22:23], v218 offset:8448
    s_add_u32 m0, s30, 98304
    s_add_u32 s11, s29, 14336
    buffer_load_dwordx4 v248, s[44:47], s11 offen sc1 lds
    s_waitcnt lgkmcnt(6)
    v_mfma_f32_32x32x16_bf16 v[128:143], v[192:195], v[8:11], v[128:143]
    ds_read_b128 v[208:211], v220 offset:22528
    ds_read_b64_tr_b16 v[16:17], v218 offset:9216
    s_waitcnt lgkmcnt(4)
    v_dot2c_f32_bf16 v176, s76, v180
    v_dot2c_f32_bf16 v177, v180, v180
    v_dot2c_f32_bf16 v176, s76, v181
    v_dot2c_f32_bf16 v177, v181, v181
    v_dot2c_f32_bf16 v176, s76, v182
    v_dot2c_f32_bf16 v177, v182, v182
    v_dot2c_f32_bf16 v176, s76, v183
    v_dot2c_f32_bf16 v177, v183, v183
    v_mfma_f32_32x32x16_bf16 v[144:159], v[196:199], v[8:11], v[144:159]
    ds_read_b128 v[212:215], v220 offset:23552
    ds_read_b64_tr_b16 v[18:19], v218 offset:9472
    s_add_u32 m0, s30, 0
    s_add_u32 s11, s29, 16384
    buffer_load_dwordx4 v248, s[44:47], s11 offen sc1 lds
    v_permlane32_swap_b32 v176, v177
    v_add_f32 v176, v176, v177
    ds_write_b32 v234, v176
    s_waitcnt lgkmcnt(5)
    v_mfma_f32_32x32x16_bf16 v[128:143], v[200:203], v[20:23], v[128:143]
    ds_read_b128 v[192:195], v220 offset:28672
    ds_read_b64_tr_b16 v[28:29], v218 offset:16384
    v_mfma_f32_32x32x16_bf16 v[144:159], v[204:207], v[20:23], v[144:159]
    ds_read_b128 v[196:199], v220 offset:29696
    ds_read_b64_tr_b16 v[30:31], v218 offset:16640
    s_waitcnt lgkmcnt(5)
    v_mfma_f32_32x32x16_bf16 v[128:143], v[208:211], v[16:19], v[128:143]
    ds_read_b128 v[200:203], v220 offset:30720
    ds_read_b64_tr_b16 v[24:25], v218 offset:17408
    v_mfma_f32_32x32x16_bf16 v[144:159], v[212:215], v[16:19], v[144:159]
    ds_read_b128 v[204:207], v220 offset:31744
    ds_read_b64_tr_b16 v[26:27], v218 offset:17664
    s_waitcnt lgkmcnt(4)
    s_waitcnt vmcnt(3)
    s_barrier
    v_mfma_f32_32x32x16_bf16 v[128:143], v[192:195], v[28:31], v[128:143]
    ds_read_b128 v[208:211], v220 offset:36864
    ds_read_b64_tr_b16 v[36:37], v218 offset:40960
    ds_read2st64_b32 v[176:177], v232 offset0:0 offset1:4
    ds_read2st64_b32 v[178:179], v232 offset0:8 offset1:12
    ds_read2st64_b32 v[180:181], v232 offset0:16 offset1:20
    ds_read2st64_b32 v[182:183], v232 offset0:24 offset1:28
    v_mfma_f32_32x32x16_bf16 v[144:159], v[196:199], v[28:31], v[144:159]
    ds_read_b128 v[212:215], v220 offset:37888
    ds_read_b64_tr_b16 v[38:39], v218 offset:41216
    s_add_u32 m0, s30, 114688
    s_add_u32 s11, s29, 18432
    buffer_load_dwordx4 v248, s[44:47], s11 offen sc1 lds
    s_waitcnt lgkmcnt(8)
    v_mfma_f32_32x32x16_bf16 v[128:143], v[200:203], v[24:27], v[128:143]
    ds_read_b128 v[192:195], v220 offset:38912
    ds_read_b64_tr_b16 v[32:33], v218 offset:41984
    s_waitcnt lgkmcnt(4)
    v_add_f32 v176, v176, v180
    v_add_f32 v177, v177, v181
    v_add_f32 v178, v178, v182
    v_mfma_f32_32x32x16_bf16 v[144:159], v[204:207], v[24:27], v[144:159]
    ds_read_b128 v[196:199], v220 offset:39936
    ds_read_b64_tr_b16 v[34:35], v218 offset:42240
    s_add_u32 m0, s30, 106496
    s_add_u32 s11, s29, 20480
    buffer_load_dwordx4 v248, s[44:47], s11 offen sc1 lds
    v_add_f32 v179, v179, v183
    v_add_f32 v176, v176, v178
    v_add_f32 v177, v177, v179
    v_add_f32 v176, v176, v177
    v_or_b32 v176, 1, v176
    s_cmp_eq_u32 s3, 4
    s_cselect_b64 exec, -1, 0
    buffer_store_dword v176, v235, s[44:47], s37 offen sc1
    s_mov_b64 exec, -1
    s_waitcnt lgkmcnt(4)
    v_mfma_f32_32x32x16_bf16 v[128:143], v[208:211], v[36:39], v[128:143]
    ds_read_b128 v[200:203], v220 offset:45056
    ds_read_b64_tr_b16 v[44:45], v218 offset:32768
    v_mfma_f32_32x32x16_bf16 v[144:159], v[212:215], v[36:39], v[144:159]
    ds_read_b128 v[204:207], v220 offset:46080
    ds_read_b64_tr_b16 v[46:47], v218 offset:33024
    s_add_u32 m0, s30, 16384
    s_add_u32 s11, s29, 22528
    buffer_load_dwordx4 v248, s[44:47], s11 offen sc1 lds
    s_waitcnt lgkmcnt(4)
    v_mfma_f32_32x32x16_bf16 v[128:143], v[192:195], v[32:35], v[128:143]
    ds_read_b128 v[208:211], v220 offset:47104
    ds_read_b64_tr_b16 v[40:41], v218 offset:33792
    v_mfma_f32_32x32x16_bf16 v[144:159], v[196:199], v[32:35], v[144:159]
    ds_read_b128 v[212:215], v220 offset:48128
    ds_read_b64_tr_b16 v[42:43], v218 offset:34048
    s_add_u32 m0, s30, 8192
    s_add_u32 s11, s29, 24576
    buffer_load_dwordx4 v248, s[44:47], s11 offen sc1 lds
    s_waitcnt lgkmcnt(4)
    s_waitcnt vmcnt(5)
    s_barrier
    v_mfma_f32_32x32x16_bf16 v[128:143], v[200:203], v[44:47], v[128:143]
    ds_read_b128 v[192:195], v220 offset:53248
    ds_read_b64_tr_b16 v[52:53], v218 offset:24576
    v_mfma_f32_32x32x16_bf16 v[144:159], v[204:207], v[44:47], v[144:159]
    ds_read_b128 v[196:199], v220 offset:54272
    ds_read_b64_tr_b16 v[54:55], v218 offset:24832
    s_add_u32 m0, s30, 122880
    s_add_u32 s11, s29, 26624
    buffer_load_dwordx4 v248, s[44:47], s11 offen sc1 lds
    s_waitcnt lgkmcnt(4)
    v_mfma_f32_32x32x16_bf16 v[128:143], v[208:211], v[40:43], v[128:143]
    ds_read_b128 v[200:203], v220 offset:55296
    ds_read_b64_tr_b16 v[48:49], v218 offset:25600
    v_mfma_f32_32x32x16_bf16 v[144:159], v[212:215], v[40:43], v[144:159]
    ds_read_b128 v[204:207], v220 offset:56320
    ds_read_b64_tr_b16 v[50:51], v218 offset:25856
    s_add_u32 m0, s30, 24576
    s_add_u32 s11, s28, 98304
    buffer_load_dwordx4 v248, s[44:47], s11 offen sc1 lds
    s_waitcnt lgkmcnt(4)
    v_mfma_f32_32x32x16_bf16 v[128:143], v[192:195], v[52:55], v[128:143]
    ds_read_b128 v[208:211], v221 offset:4096
    ds_read_b64_tr_b16 v[60:61], v217 offset:40960
    v_mfma_f32_32x32x16_bf16 v[144:159], v[196:199], v[52:55], v[144:159]
    ds_read_b128 v[212:215], v221 offset:5120
    ds_read_b64_tr_b16 v[62:63], v217 offset:41216
    s_add_u32 m0, s30, 32768
    s_add_u32 s11, s28, 106496
    buffer_load_dwordx4 v248, s[44:47], s11 offen sc1 lds
    s_waitcnt lgkmcnt(4)
    v_mfma_f32_32x32x16_bf16 v[128:143], v[200:203], v[48:51], v[128:143]
    ds_read_b128 v[192:195], v221 offset:6144
    ds_read_b64_tr_b16 v[56:57], v217 offset:41984
    v_mfma_f32_32x32x16_bf16 v[144:159], v[204:207], v[48:51], v[144:159]
    ds_read_b128 v[196:199], v221 offset:7168
    ds_read_b64_tr_b16 v[58:59], v217 offset:42240
    s_waitcnt lgkmcnt(4)
    s_waitcnt vmcnt(6)
    s_barrier
    v_mfma_f32_32x32x16_bf16 v[128:143], v[208:211], v[60:63], v[128:143]
    ds_read_b128 v[200:203], v221 offset:12288
    ds_read_b64_tr_b16 v[68:69], v216 offset:0
    v_mfma_f32_32x32x16_bf16 v[144:159], v[212:215], v[60:63], v[144:159]
    ds_read_b128 v[204:207], v221 offset:13312
    ds_read_b64_tr_b16 v[70:71], v216 offset:256
    s_add_u32 m0, s30, 139264
    s_add_u32 s11, s29, 28672
    buffer_load_dwordx4 v248, s[44:47], s11 offen sc1 lds
    s_waitcnt lgkmcnt(4)
    buffer_load_dword v184, v235, s[44:47], s38 offen offset:0 sc1
    v_mfma_f32_32x32x16_bf16 v[128:143], v[192:195], v[56:59], v[128:143]
    ds_read_b128 v[208:211], v221 offset:14336
    ds_read_b64_tr_b16 v[64:65], v216 offset:1024
    v_mfma_f32_32x32x16_bf16 v[144:159], v[196:199], v[56:59], v[144:159]
    ds_read_b128 v[212:215], v221 offset:15360
    ds_read_b64_tr_b16 v[66:67], v216 offset:1280
    s_add_u32 m0, s30, 131072
    s_add_u32 s11, s29, 30720
    buffer_load_dwordx4 v248, s[44:47], s11 offen sc1 lds
    s_waitcnt lgkmcnt(4)
    buffer_load_dword v185, v235, s[44:47], s38 offen offset:256 sc1
    v_mfma_f32_32x32x16_bf16 v[128:143], v[200:203], v[68:71], v[128:143]
    ds_read_b128 v[192:195], v221 offset:20480
    ds_read_b64_tr_b16 v[76:77], v218 offset:8192
    v_mfma_f32_32x32x16_bf16 v[144:159], v[204:207], v[68:71], v[144:159]
    ds_read_b128 v[196:199], v221 offset:21504
    ds_read_b64_tr_b16 v[78:79], v218 offset:8448
    s_add_u32 m0, s30, 40960
    s_add_u32 s11, s28, 114688
    buffer_load_dwordx4 v248, s[44:47], s11 offen sc1 lds
    s_waitcnt lgkmcnt(4)
    buffer_load_dword v186, v235, s[44:47], s38 offen offset:512 sc1
    v_mfma_f32_32x32x16_bf16 v[128:143], v[208:211], v[64:67], v[128:143]
    ds_read_b128 v[200:203], v221 offset:22528
    ds_read_b64_tr_b16 v[72:73], v218 offset:9216
    v_mfma_f32_32x32x16_bf16 v[144:159], v[212:215], v[64:67], v[144:159]
    ds_read_b128 v[204:207], v221 offset:23552
    ds_read_b64_tr_b16 v[74:75], v218 offset:9472
    s_add_u32 m0, s30, 49152
    s_add_u32 s11, s28, 122880
    buffer_load_dwordx4 v248, s[44:47], s11 offen sc1 lds
    s_waitcnt lgkmcnt(4)
    s_waitcnt vmcnt(11)
    s_barrier
    buffer_load_dword v187, v235, s[44:47], s38 offen offset:768 sc1
    v_mfma_f32_32x32x16_bf16 v[128:143], v[192:195], v[76:79], v[128:143]
    ds_read_b128 v[208:211], v221 offset:28672
    ds_read_b64_tr_b16 v[84:85], v218 offset:0
    v_mfma_f32_32x32x16_bf16 v[144:159], v[196:199], v[76:79], v[144:159]
    ds_read_b128 v[212:215], v221 offset:29696
    ds_read_b64_tr_b16 v[86:87], v218 offset:256
    s_add_u32 m0, s30, 0
    s_add_u32 s11, s28, 0
    buffer_load_dwordx4 v248, s[44:47], s11 offen sc1 lds
    s_waitcnt lgkmcnt(4)
    v_mfma_f32_32x32x16_bf16 v[128:143], v[200:203], v[72:75], v[128:143]
    ds_read_b128 v[192:195], v221 offset:30720
    ds_read_b64_tr_b16 v[80:81], v218 offset:1024
    v_mfma_f32_32x32x16_bf16 v[144:159], v[204:207], v[72:75], v[144:159]
    ds_read_b128 v[196:199], v221 offset:31744
    ds_read_b64_tr_b16 v[82:83], v218 offset:1280
    s_add_u32 m0, s30, 147456
    s_add_u32 s11, s32, 0
    buffer_load_dwordx4 v248, s[44:47], s11 offen sc1 lds
    s_waitcnt lgkmcnt(4)
    v_mfma_f32_32x32x16_bf16 v[128:143], v[208:211], v[84:87], v[128:143]
    ds_read_b128 v[200:203], v221 offset:36864
    ds_read_b64_tr_b16 v[92:93], v216 offset:16384
    v_mfma_f32_32x32x16_bf16 v[144:159], v[212:215], v[84:87], v[144:159]
    ds_read_b128 v[204:207], v221 offset:37888
    ds_read_b64_tr_b16 v[94:95], v216 offset:16640
    s_add_u32 m0, s30, 155648
    s_add_u32 s11, s32, 8192
    buffer_load_dwordx4 v248, s[44:47], s11 offen sc1 lds
    s_waitcnt lgkmcnt(4)
    v_mfma_f32_32x32x16_bf16 v[128:143], v[192:195], v[80:83], v[128:143]
    ds_read_b128 v[208:211], v221 offset:38912
    ds_read_b64_tr_b16 v[88:89], v216 offset:17408
    v_mfma_f32_32x32x16_bf16 v[144:159], v[196:199], v[80:83], v[144:159]
    ds_read_b128 v[212:215], v221 offset:39936
    ds_read_b64_tr_b16 v[90:91], v216 offset:17664
    s_add_u32 m0, s30, 57344
    s_add_u32 s11, s28, 8192
    buffer_load_dwordx4 v248, s[44:47], s11 offen sc1 lds
    s_waitcnt lgkmcnt(4)
    s_waitcnt vmcnt(12)
    s_barrier
    v_mfma_f32_32x32x16_bf16 v[128:143], v[200:203], v[92:95], v[128:143]
    ds_read_b128 v[192:195], v220 offset:28672
    ds_read_b64_tr_b16 v[100:101], v216 offset:8192
    v_mfma_f32_32x32x16_bf16 v[144:159], v[204:207], v[92:95], v[144:159]
    ds_read_b128 v[196:199], v220 offset:29696
    ds_read_b64_tr_b16 v[102:103], v216 offset:8448
    s_add_u32 m0, s30, 65536
    s_add_u32 s11, s28, 16384
    buffer_load_dwordx4 v248, s[44:47], s11 offen sc1 lds
    s_waitcnt lgkmcnt(4)
    v_mfma_f32_32x32x16_bf16 v[128:143], v[208:211], v[88:91], v[128:143]
    ds_read_b128 v[200:203], v220 offset:30720
    ds_read_b64_tr_b16 v[96:97], v216 offset:9216
    v_mfma_f32_32x32x16_bf16 v[144:159], v[212:215], v[88:91], v[144:159]
    ds_read_b128 v[204:207], v220 offset:31744
    ds_read_b64_tr_b16 v[98:99], v216 offset:9472
    s_add_u32 m0, s30, 73728
    s_add_u32 s11, s33, 0
    buffer_load_dwordx4 v227, s[52:55], s11 offen lds
    s_waitcnt lgkmcnt(4)
    v_mfma_f32_32x32x16_bf16 v[128:143], v[192:195], v[100:103], v[128:143]
    ds_read_b128 v[208:211], v220 offset:36864
    ds_read_b64_tr_b16 v[108:109], v218 offset:16384
    s_waitcnt vmcnt(6)
    v_and_b32 v188, v184, v185
    v_and_b32 v189, v186, v187
    v_and_b32 v188, v188, v189
    v_and_b32 v188, 1, v188
    v_cmp_eq_u32 vcc, 0, v188
    s_nop 0
    s_cbranch_vccnz L_stwait1
L_stok1:
    v_mfma_f32_32x32x16_bf16 v[144:159], v[196:199], v[100:103], v[144:159]
    ds_read_b128 v[212:215], v220 offset:37888
    ds_read_b64_tr_b16 v[110:111], v218 offset:16640
    s_add_u32 m0, s30, 81920
    s_add_u32 s11, s28, 24576
    buffer_load_dwordx4 v248, s[44:47], s11 offen sc1 lds
    v_add_f32 v184, v184, v185
    v_add_f32 v186, v186, v187
    v_add_f32 v184, v184, v186
    v_mov_b32 v185, v184
    s_waitcnt lgkmcnt(4)
    v_mfma_f32_32x32x16_bf16 v[128:143], v[200:203], v[96:99], v[128:143]
    ds_read_b128 v[192:195], v220 offset:38912
    ds_read_b64_tr_b16 v[104:105], v218 offset:17408
    v_permlane32_swap_b32 v184, v185
    v_mul_f32 v236, 0x3b000000, v184
    v_mul_f32 v186, v236, v236
    v_mfma_f32_32x32x16_bf16 v[144:159], v[204:207], v[96:99], v[144:159]
    ds_read_b128 v[196:199], v220 offset:39936
    ds_read_b64_tr_b16 v[106:107], v218 offset:17664
    s_add_u32 m0, s30, 98304
    s_add_u32 s11, s33, 16384
    buffer_load_dwordx4 v227, s[52:55], s11 offen lds
    v_mul_f32 v237, 0x3b000000, v185
    v_sub_f32 v237, v237, v186
    v_max_f32 v237, 0, v237
    v_cvt_pk_bf16_f32 v186, v236, v237
    v_lshlrev_b32 v236, 16, v186
    v_and_b32 v237, 0xffff0000, v186
    s_waitcnt lgkmcnt(4)
    s_barrier
    v_mfma_f32_32x32x16_bf16 v[128:143], v[208:211], v[108:111], v[128:143]
    ds_read_b128 v[200:203], v220 offset:45056
    ds_read_b64_tr_b16 v[116:117], v218 offset:32768
    v_add_f32 v237, 0x3727c5ac, v237
    v_cvt_pk_bf16_f32 v186, v237, v237
    v_lshlrev_b32 v237, 16, v186
    v_mfma_f32_32x32x16_bf16 v[144:159], v[212:215], v[108:111], v[144:159]
    ds_read_b128 v[204:207], v220 offset:46080
    ds_read_b64_tr_b16 v[118:119], v218 offset:33024
    s_add_u32 m0, s30, 8192
    s_add_u32 s11, s28, 32768
    buffer_load_dwordx4 v248, s[44:47], s11 offen sc1 lds
    v_sqrt_f32 v237, v237
    s_nop 0
    v_cvt_pk_bf16_f32 v186, v237, v237
    v_lshlrev_b32 v237, 16, v186
    v_xor_b32 v236, 0x80000000, v236
    v_lshrrev_b32 v240, 16, v236
    s_waitcnt lgkmcnt(4)
    v_mfma_f32_32x32x16_bf16 v[128:143], v[192:195], v[104:107], v[128:143]
    ds_read_b128 v[208:211], v220 offset:47104
    ds_read_b64_tr_b16 v[112:113], v218 offset:33792
    v_or_b32 v240, v240, v236
    v_mov_b32 v241, v240
    v_mov_b32 v242, v240
    v_mfma_f32_32x32x16_bf16 v[144:159], v[196:199], v[104:107], v[144:159]
    ds_read_b128 v[212:215], v220 offset:48128
    ds_read_b64_tr_b16 v[114:115], v218 offset:34048
    s_add_u32 m0, s30, 16384
    s_add_u32 s11, s33, 32768
    buffer_load_dwordx4 v227, s[52:55], s11 offen lds
    v_mov_b32 v243, v240
    v_rcp_f32 v236, v237
    v_mul_f32 v237, v237, v237
    v_mul_f32 v236, 0xbfb8aa3b, v236
    s_waitcnt lgkmcnt(4)
    v_mfma_f32_32x32x16_bf16 v[128:143], v[200:203], v[116:119], v[128:143]
    ds_read_b128 v[192:195], v220 offset:53248
    ds_read_b64_tr_b16 v[124:125], v218 offset:24576
    v_mfma_f32_32x32x16_bf16 v[144:159], v[204:207], v[116:119], v[144:159]
    ds_read_b128 v[196:199], v220 offset:54272
    ds_read_b64_tr_b16 v[126:127], v218 offset:24832
    s_add_u32 m0, s30, 24576
    s_add_u32 s11, s28, 40960
    buffer_load_dwordx4 v248, s[44:47], s11 offen sc1 lds
    s_waitcnt lgkmcnt(4)
    v_mfma_f32_32x32x16_bf16 v[128:143], v[208:211], v[112:115], v[128:143]
    ds_read_b128 v[200:203], v220 offset:55296
    ds_read_b64_tr_b16 v[120:121], v218 offset:25600
    v_mfma_f32_32x32x16_bf16 v[144:159], v[212:215], v[112:115], v[144:159]
    ds_read_b128 v[204:207], v220 offset:56320
    ds_read_b64_tr_b16 v[122:123], v218 offset:25856
    s_add_u32 m0, s30, 90112
    s_add_u32 s11, s33, 49152
    buffer_load_dwordx4 v227, s[52:55], s11 offen lds
    s_waitcnt lgkmcnt(4)
    s_waitcnt vmcnt(9)
    s_barrier
    v_mfma_f32_32x32x16_bf16 v[128:143], v[192:195], v[124:127], v[128:143]
    ds_read_b128 v[208:211], v220 offset:1024
    v_mfma_f32_32x32x16_bf16 v[144:159], v[196:199], v[124:127], v[144:159]
    ds_read_b64_tr_b16 v[212:213], v229 offset:128
    ds_read_b64_tr_b16 v[214:215], v229 offset:3712
    s_add_u32 m0, s30, 32768
    s_add_u32 s11, s28, 49152
    buffer_load_dwordx4 v248, s[44:47], s11 offen sc1 lds
    s_waitcnt lgkmcnt(3)
    v_mfma_f32_32x32x16_bf16 v[128:143], v[200:203], v[120:123], v[128:143]
    ds_read_b64_tr_b16 v[192:193], v229 offset:576
    ds_read_b64_tr_b16 v[194:195], v229 offset:4160
    v_mfma_f32_32x32x16_bf16 v[144:159], v[204:207], v[120:123], v[144:159]
    ds_read_b64_tr_b16 v[196:197], v229 offset:192
    ds_read_b64_tr_b16 v[198:199], v229 offset:3776
    s_add_u32 m0, s30, 40960
    s_add_u32 s11, s33, 65536
    buffer_load_dwordx4 v227, s[52:55], s11 offen lds
    s_waitcnt lgkmcnt(6)
    v_mfma_f32_32x32x16_bf16 v[160:175], v[208:211], v[4:7], 0
    ds_read_b64_tr_b16 v[200:201], v229 offset:640
    ds_read_b64_tr_b16 v[202:203], v229 offset:4224
    s_waitcnt lgkmcnt(6)
    v_mfma_f32_32x32x16_bf16 v[128:143], v[212:215], v[240:243], v[128:143]
    ds_read_b64_tr_b16 v[204:205], v229 offset:320
    ds_read_b64_tr_b16 v[206:207], v229 offset:3904
    s_add_u32 m0, s30, 106496
    s_add_u32 s11, s28, 57344
    buffer_load_dwordx4 v248, s[44:47], s11 offen sc1 lds
    s_waitcnt lgkmcnt(6)
    v_mfma_f32_32x32x16_bf16 v[128:143], v[192:195], v[240:243], v[128:143]
    ds_read_b64_tr_b16 v[208:209], v229 offset:768
    ds_read_b64_tr_b16 v[210:211], v229 offset:4352
    s_waitcnt lgkmcnt(6)
    v_mfma_f32_32x32x16_bf16 v[144:159], v[196:199], v[240:243], v[144:159]
    ds_read_b64_tr_b16 v[212:213], v229 offset:832
    ds_read_b64_tr_b16 v[214:215], v229 offset:4416
    s_add_u32 m0, s30, 114688
    s_add_u32 s11, s33, 81920
    buffer_load_dwordx4 v227, s[52:55], s11 offen lds
    s_waitcnt lgkmcnt(6)
    v_mfma_f32_32x32x16_bf16 v[144:159], v[200:203], v[240:243], v[144:159]
    ds_read_b128 v[192:195], v220 offset:3072
    s_waitcnt lgkmcnt(5)
    v_mfma_f32_32x32x16_bf16 v[160:175], v[204:207], v[240:243], v[160:175]
    ds_read_b128 v[196:199], v220 offset:5120
    v_mul_f32 v216, v236, v128
    v_mul_f32 v217, v236, v129
    v_mul_f32 v218, v236, v130
    v_mul_f32 v219, v236, v131
    v_exp_f32 v216, v216
    v_exp_f32 v217, v217
    s_waitcnt lgkmcnt(4)
    s_waitcnt vmcnt(8)
    s_barrier
    v_mfma_f32_32x32x16_bf16 v[160:175], v[208:211], v[240:243], v[160:175]
    ds_read_b128 v[200:203], v220 offset:7168
    v_exp_f32 v218, v218
    v_exp_f32 v219, v219
    v_mul_f32 v128, v128, v136
    v_mul_f32 v129, v129, v137
    v_mul_f32 v130, v130, v138
    v_mul_f32 v131, v131, v139
    s_waitcnt lgkmcnt(3)
    v_mfma_f32_32x32x16_bf16 v[176:191], v[212:215], v[240:243], 0
    ds_read_b128 v[204:207], v221 offset:1024
    s_add_u32 m0, s30, 49152
    s_add_u32 s11, s28, 65536
    buffer_load_dwordx4 v248, s[44:47], s11 offen sc1 lds
    v_fma_f32 v216, v216, v237, v237
    v_fma_f32 v217, v217, v237, v237
    v_fma_f32 v218, v218, v237, v237
    v_fma_f32 v219, v219, v237, v237
    v_rcp_f32 v216, v216
    s_waitcnt lgkmcnt(3)
    v_mfma_f32_32x32x16_bf16 v[160:175], v[192:195], v[0:3], v[160:175]
    ds_read_b128 v[208:211], v221 offset:3072
    v_rcp_f32 v217, v217
    v_rcp_f32 v218, v218
    v_rcp_f32 v219, v219
    v_mul_f32 v128, v128, v216
    v_mul_f32 v129, v129, v217
    s_waitcnt lgkmcnt(3)
    v_mfma_f32_32x32x16_bf16 v[160:175], v[196:199], v[12:15], v[160:175]
    ds_read_b128 v[212:215], v221 offset:5120
    s_add_u32 m0, s30, 122880
    s_add_u32 s11, s33, 98304
    buffer_load_dwordx4 v227, s[52:55], s11 offen lds
    v_mul_f32 v130, v130, v218
    v_mul_f32 v131, v131, v219
    v_cvt_pk_bf16_f32 v244, v128, v129
    v_cvt_pk_bf16_f32 v245, v130, v131
    v_mul_f32 v216, v236, v132
    v_mul_f32 v217, v236, v133
    s_waitcnt lgkmcnt(3)
    v_mfma_f32_32x32x16_bf16 v[160:175], v[200:203], v[8:11], v[160:175]
    ds_read_b128 v[192:195], v221 offset:7168
    v_mul_f32 v218, v236, v134
    v_mul_f32 v219, v236, v135
    v_exp_f32 v216, v216
    v_exp_f32 v217, v217
    v_exp_f32 v218, v218
    s_waitcnt lgkmcnt(3)
    v_mfma_f32_32x32x16_bf16 v[160:175], v[204:207], v[20:23], v[160:175]
    ds_read_b128 v[196:199], v221 offset:9216
    ds_read_b64_tr_b16 v[4:5], v223 offset:16384
    s_add_u32 m0, s30, 131072
    s_add_u32 s11, s28, 73728
    buffer_load_dwordx4 v248, s[44:47], s11 offen sc1 lds
    v_exp_f32 v219, v219
    v_mul_f32 v132, v132, v140
    v_mul_f32 v133, v133, v141
    v_mul_f32 v134, v134, v142
    v_mul_f32 v135, v135, v143
    s_waitcnt lgkmcnt(4)
    v_mfma_f32_32x32x16_bf16 v[160:175], v[208:211], v[16:19], v[160:175]
    ds_read_b128 v[200:203], v221 offset:11264
    ds_read_b64_tr_b16 v[6:7], v223 offset:17408
    v_fma_f32 v216, v216, v237, v237
    v_fma_f32 v217, v217, v237, v237
    v_fma_f32 v218, v218, v237, v237
    v_fma_f32 v219, v219, v237, v237
    v_rcp_f32 v216, v216
    v_rcp_f32 v217, v217
    s_waitcnt lgkmcnt(5)
    v_mfma_f32_32x32x16_bf16 v[160:175], v[212:215], v[28:31], v[160:175]
    ds_read_b128 v[204:207], v221 offset:13312
    ds_read_b64_tr_b16 v[12:13], v225 offset:16384
    s_add_u32 m0, s30, 139264
    s_add_u32 s11, s33, 114688
    buffer_load_dwordx4 v227, s[52:55], s11 offen lds
    v_rcp_f32 v218, v218
    v_rcp_f32 v219, v219
    v_mul_f32 v132, v132, v216
    v_mul_f32 v133, v133, v217
    s_waitcnt lgkmcnt(6)
    v_mfma_f32_32x32x16_bf16 v[160:175], v[192:195], v[24:27], v[160:175]
    ds_read_b128 v[208:211], v221 offset:15360
    ds_read_b64_tr_b16 v[14:15], v225 offset:17408
    v_mul_f32 v134, v134, v218
    v_mul_f32 v135, v135, v219
    v_cvt_pk_bf16_f32 v246, v132, v133
    v_cvt_pk_bf16_f32 v247, v134, v135
    buffer_store_dwordx4 v[244:247], v248, s[44:47], s31 offen offset:0 sc1
    v_mul_f32 v216, v236, v144
    v_mul_f32 v217, v236, v145
    v_mul_f32 v218, v236, v146
    s_waitcnt lgkmcnt(7)
    v_mfma_f32_32x32x16_bf16 v[160:175], v[196:199], v[36:39], v[160:175]
    ds_read_b128 v[212:215], v221 offset:25600
    ds_read_b64_tr_b16 v[20:21], v223 offset:40960
    v_mul_f32 v219, v236, v147
    v_exp_f32 v216, v216
    v_exp_f32 v217, v217
    v_exp_f32 v218, v218
    v_exp_f32 v219, v219
    s_waitcnt lgkmcnt(7)
    s_waitcnt vmcnt(9)
    s_barrier
    v_mfma_f32_32x32x16_bf16 v[160:175], v[200:203], v[32:35], v[160:175]
    ds_read_b128 v[192:195], v221 offset:27648
    ds_read_b64_tr_b16 v[22:23], v223 offset:41984
    v_mul_f32 v144, v144, v152
    v_mul_f32 v145, v145, v153
    v_mul_f32 v146, v146, v154
    v_mul_f32 v147, v147, v155
    v_fma_f32 v216, v216, v237, v237
    v_fma_f32 v217, v217, v237, v237
    v_fma_f32 v218, v218, v237, v237
    s_waitcnt lgkmcnt(7)
    v_mfma_f32_32x32x16_bf16 v[160:175], v[204:207], v[44:47], v[160:175]
    ds_read_b128 v[196:199], v221 offset:29696
    ds_read_b64_tr_b16 v[28:29], v225 offset:40960
    s_add_u32 m0, s30, 57344
    s_add_u32 s11, s28, 81920
    buffer_load_dwordx4 v248, s[44:47], s11 offen sc1 lds
    v_fma_f32 v219, v219, v237, v237
    v_rcp_f32 v216, v216
    v_rcp_f32 v217, v217
    v_rcp_f32 v218, v218
    s_waitcnt lgkmcnt(7)
    v_mfma_f32_32x32x16_bf16 v[160:175], v[208:211], v[40:43], v[160:175]
    ds_read_b128 v[200:203], v221 offset:31744
    ds_read_b64_tr_b16 v[30:31], v225 offset:41984
    v_rcp_f32 v219, v219
    v_mul_f32 v144, v144, v216
    v_mul_f32 v145, v145, v217
    v_mul_f32 v146, v146, v218
    v_mul_f32 v147, v147, v219
    v_cvt_pk_bf16_f32 v136, v144, v145
    s_waitcnt lgkmcnt(7)
    v_mfma_f32_32x32x16_bf16 v[160:175], v[212:215], v[52:55], v[160:175]
    ds_read_b128 v[204:207], v220 offset:9216
    ds_read_b64_tr_b16 v[36:37], v254 offset:16384
    s_add_u32 m0, s30, 147456
    s_add_u32 s11, s28, 90112
    buffer_load_dwordx4 v248, s[44:47], s11 offen sc1 lds
    v_cvt_pk_bf16_f32 v137, v146, v147
    v_mul_f32 v216, v236, v148
    v_mul_f32 v217, v236, v149
    v_mul_f32 v218, v236, v150
    v_mul_f32 v219, v236, v151
    v_exp_f32 v216, v216
    s_waitcnt lgkmcnt(7)
    v_mfma_f32_32x32x16_bf16 v[160:175], v[192:195], v[48:51], v[160:175]
    ds_read_b128 v[208:211], v220 offset:11264
    ds_read_b64_tr_b16 v[38:39], v254 offset:17408
    v_exp_f32 v217, v217
    v_exp_f32 v218, v218
    v_exp_f32 v219, v219
    v_mul_f32 v148, v148, v156
    s_waitcnt lgkmcnt(7)
    v_mfma_f32_32x32x16_bf16 v[160:175], v[196:199], v[60:63], v[160:175]
    ds_read_b128 v[212:215], v220 offset:13312
    ds_read_b64_tr_b16 v[44:45], v255 offset:16384
    s_add_u32 m0, s30, 155648
    s_nop 0
    buffer_load_dwordx4 v248, s[44:47], s75 offen sc1 lds
    v_mul_f32 v149, v149, v157
    v_mul_f32 v150, v150, v158
    v_mul_f32 v151, v151, v159
    v_fma_f32 v216, v216, v237, v237
    v_fma_f32 v217, v217, v237, v237
    v_fma_f32 v218, v218, v237, v237
    s_waitcnt lgkmcnt(7)
    v_mfma_f32_32x32x16_bf16 v[160:175], v[200:203], v[56:59], v[160:175]
    ds_read_b128 v[192:195], v220 offset:15360
    ds_read_b64_tr_b16 v[46:47], v255 offset:17408
    v_fma_f32 v219, v219, v237, v237
    v_rcp_f32 v216, v216
    v_rcp_f32 v217, v217
    v_rcp_f32 v218, v218
    v_rcp_f32 v219, v219
    s_waitcnt lgkmcnt(7)
    v_mfma_f32_32x32x16_bf16 v[160:175], v[204:207], v[68:71], v[160:175]
    ds_read_b128 v[196:199], v220 offset:25600
    ds_read_b64_tr_b16 v[52:53], v223 offset:32768
    v_mul_f32 v148, v148, v216
    v_mul_f32 v149, v149, v217
    v_mul_f32 v150, v150, v218
    v_mul_f32 v151, v151, v219
    v_cvt_pk_bf16_f32 v138, v148, v149
    v_cvt_pk_bf16_f32 v139, v150, v151
    buffer_store_dwordx4 v[136:139], v248, s[44:47], s31 offen offset:1024 sc1
    s_waitcnt lgkmcnt(7)
    v_mfma_f32_32x32x16_bf16 v[160:175], v[208:211], v[64:67], v[160:175]
    ds_read_b128 v[200:203], v220 offset:27648
    ds_read_b64_tr_b16 v[54:55], v223 offset:33792
    s_waitcnt lgkmcnt(7)
    v_mfma_f32_32x32x16_bf16 v[160:175], v[212:215], v[76:79], v[160:175]
    ds_read_b128 v[204:207], v220 offset:29696
    ds_read_b64_tr_b16 v[60:61], v225 offset:32768
    s_waitcnt lgkmcnt(7)
    s_waitcnt vmcnt(5)
    s_barrier
    v_mfma_f32_32x32x16_bf16 v[160:175], v[192:195], v[72:75], v[160:175]
    ds_read_b128 v[208:211], v220 offset:31744
    ds_read_b64_tr_b16 v[62:63], v225 offset:33792
    s_waitcnt lgkmcnt(7)
    v_mfma_f32_32x32x16_bf16 v[160:175], v[196:199], v[84:87], v[160:175]
    ds_read_b128 v[212:215], v220 offset:33792
    ds_read_b64_tr_b16 v[68:69], v254 offset:40960
    s_add_u32 m0, s30, 65536
    s_add_u32 s11, s33, 131072
    buffer_load_dwordx4 v227, s[52:55], s11 offen lds
    s_waitcnt lgkmcnt(7)
    v_mfma_f32_32x32x16_bf16 v[160:175], v[200:203], v[80:83], v[160:175]
    ds_read_b128 v[192:195], v220 offset:35840
    ds_read_b64_tr_b16 v[70:71], v254 offset:41984
    s_waitcnt lgkmcnt(7)
    v_mfma_f32_32x32x16_bf16 v[160:175], v[204:207], v[92:95], v[160:175]
    ds_read_b128 v[196:199], v220 offset:37888
    ds_read_b64_tr_b16 v[76:77], v255 offset:40960
    s_add_u32 m0, s30, 73728
    s_add_u32 s11, s33, 147456
    buffer_load_dwordx4 v227, s[52:55], s11 offen lds
    s_waitcnt lgkmcnt(7)
    v_mfma_f32_32x32x16_bf16 v[160:175], v[208:211], v[88:91], v[160:175]
    ds_read_b128 v[200:203], v220 offset:39936
    ds_read_b64_tr_b16 v[78:79], v255 offset:41984
    s_waitcnt lgkmcnt(7)
    v_mfma_f32_32x32x16_bf16 v[160:175], v[212:215], v[100:103], v[160:175]
    ds_read_b128 v[204:207], v222 offset:1024
    ds_read_b64_tr_b16 v[84:85], v224 offset:8192
    s_add_u32 m0, s30, 81920
    s_add_u32 s11, s33, 163840
    buffer_load_dwordx4 v227, s[52:55], s11 offen lds
    s_waitcnt lgkmcnt(7)
    v_mfma_f32_32x32x16_bf16 v[160:175], v[192:195], v[96:99], v[160:175]
    ds_read_b128 v[208:211], v222 offset:3072
    ds_read_b64_tr_b16 v[86:87], v224 offset:9216
    s_waitcnt lgkmcnt(7)
    v_mfma_f32_32x32x16_bf16 v[160:175], v[196:199], v[108:111], v[160:175]
    ds_read_b128 v[212:215], v222 offset:5120
    ds_read_b64_tr_b16 v[92:93], v226 offset:8192
    s_add_u32 m0, s30, 98304
    s_add_u32 s11, s33, 180224
    buffer_load_dwordx4 v227, s[52:55], s11 offen lds
    s_waitcnt lgkmcnt(7)
    v_mfma_f32_32x32x16_bf16 v[160:175], v[200:203], v[104:107], v[160:175]
    ds_read_b128 v[192:195], v222 offset:7168
    ds_read_b64_tr_b16 v[94:95], v226 offset:9216
    s_waitcnt lgkmcnt(7)
    v_mfma_f32_32x32x16_bf16 v[160:175], v[204:207], v[116:119], v[160:175]
    ds_read_b128 v[196:199], v220 offset:50176
    ds_read_b64_tr_b16 v[100:101], v224 offset:16384
    s_waitcnt lgkmcnt(7)
    v_mfma_f32_32x32x16_bf16 v[160:175], v[208:211], v[112:115], v[160:175]
    ds_read_b128 v[200:203], v220 offset:52224
    ds_read_b64_tr_b16 v[102:103], v224 offset:17408
    s_waitcnt lgkmcnt(7)
    v_mfma_f32_32x32x16_bf16 v[160:175], v[212:215], v[124:127], v[160:175]
    ds_read_b128 v[204:207], v220 offset:54272
    ds_read_b64_tr_b16 v[108:109], v226 offset:16384
    s_waitcnt lgkmcnt(7)
    v_mfma_f32_32x32x16_bf16 v[160:175], v[192:195], v[120:123], v[160:175]
    ds_read_b128 v[208:211], v220 offset:56320
    ds_read_b64_tr_b16 v[110:111], v226 offset:17408
    s_waitcnt lgkmcnt(7)
    v_mfma_f32_32x32x16_bf16 v[176:191], v[196:199], v[0:3], v[176:191]
    ds_read_b128 v[212:215], v222 offset:25600
    ds_read_b64_tr_b16 v[116:117], v224 offset:32768
    s_waitcnt lgkmcnt(7)
    s_waitcnt vmcnt(4)
    s_barrier
    v_mfma_f32_32x32x16_bf16 v[176:191], v[200:203], v[8:11], v[176:191]
    ds_read_b128 v[192:195], v222 offset:27648
    ds_read_b64_tr_b16 v[118:119], v224 offset:33792
    s_add_u32 s11, s16, 0x1000
    s_cmp_eq_u32 s3, 4
    s_cselect_b64 exec, 1, 0
    buffer_atomic_add v253, v252, s[44:47], s11 offen sc1
    s_mov_b64 exec, -1
    s_waitcnt lgkmcnt(7)
    v_mfma_f32_32x32x16_bf16 v[176:191], v[204:207], v[16:19], v[176:191]
    ds_read_b128 v[196:199], v222 offset:29696
    ds_read_b64_tr_b16 v[124:125], v226 offset:32768
    s_add_u32 m0, s30, 16384
    s_add_u32 s11, s33, 196608
    buffer_load_dwordx4 v227, s[52:55], s11 offen lds
    v_mul_f32 v216, v236, v160
    v_mul_f32 v217, v236, v161
    v_mul_f32 v218, v236, v162
    v_mul_f32 v219, v236, v163
    v_exp_f32 v216, v216
    s_waitcnt lgkmcnt(7)
    v_mfma_f32_32x32x16_bf16 v[176:191], v[208:211], v[24:27], v[176:191]
    ds_read_b128 v[200:203], v222 offset:31744
    ds_read_b64_tr_b16 v[126:127], v226 offset:33792
    v_exp_f32 v217, v217
    v_exp_f32 v218, v218
    v_exp_f32 v219, v219
    v_mul_f32 v160, v160, v168
    s_waitcnt lgkmcnt(7)
    v_mfma_f32_32x32x16_bf16 v[176:191], v[212:215], v[32:35], v[176:191]
    ds_read_b128 v[204:207], v221 offset:1024
    s_add_u32 m0, s30, 24576
    s_add_u32 s11, s33, 212992
    buffer_load_dwordx4 v227, s[52:55], s11 offen lds
    v_mul_f32 v161, v161, v169
    v_mul_f32 v162, v162, v170
    v_mul_f32 v163, v163, v171
    v_fma_f32 v216, v216, v237, v237
    v_fma_f32 v217, v217, v237, v237
    v_fma_f32 v218, v218, v237, v237
    s_waitcnt lgkmcnt(6)
    v_mfma_f32_32x32x16_bf16 v[176:191], v[192:195], v[40:43], v[176:191]
    ds_read_b128 v[208:211], v221 offset:3072
    v_fma_f32 v219, v219, v237, v237
    v_rcp_f32 v216, v216
    v_rcp_f32 v217, v217
    v_rcp_f32 v218, v218
    s_waitcnt lgkmcnt(5)
    v_mfma_f32_32x32x16_bf16 v[176:191], v[196:199], v[48:51], v[176:191]
    ds_read_b128 v[212:215], v221 offset:5120
    s_add_u32 m0, s30, 32768
    s_add_u32 s11, s33, 229376
    buffer_load_dwordx4 v227, s[52:55], s11 offen lds
    v_rcp_f32 v219, v219
    v_mul_f32 v160, v160, v216
    v_mul_f32 v161, v161, v217
    v_mul_f32 v162, v162, v218
    v_mul_f32 v163, v163, v219
    s_waitcnt lgkmcnt(4)
    v_mfma_f32_32x32x16_bf16 v[176:191], v[200:203], v[56:59], v[176:191]
    ds_read_b128 v[192:195], v221 offset:7168
    v_cvt_pk_bf16_f32 v244, v160, v161
    v_cvt_pk_bf16_f32 v245, v162, v163
    v_mul_f32 v216, v236, v164
    v_mul_f32 v217, v236, v165
    v_mul_f32 v218, v236, v166
    v_mul_f32 v219, v236, v167
    v_exp_f32 v216, v216
    s_waitcnt lgkmcnt(3)
    v_mfma_f32_32x32x16_bf16 v[176:191], v[204:207], v[64:67], v[176:191]
    ds_read_b128 v[196:199], v222 offset:41984
    s_add_u32 m0, s30, 40960
    s_add_u32 s11, s33, 245760
    buffer_load_dwordx4 v227, s[52:55], s11 offen lds
    v_exp_f32 v217, v217
    v_exp_f32 v218, v218
    v_exp_f32 v219, v219
    s_waitcnt lgkmcnt(3)
    s_barrier
    v_mfma_f32_32x32x16_bf16 v[176:191], v[208:211], v[72:75], v[176:191]
    ds_read_b128 v[200:203], v222 offset:44032
    v_mul_f32 v164, v164, v172
    v_mul_f32 v165, v165, v173
    v_mul_f32 v166, v166, v174
    v_mul_f32 v167, v167, v175
    v_fma_f32 v216, v216, v237, v237
    v_fma_f32 v217, v217, v237, v237
    s_waitcnt lgkmcnt(3)
    v_mfma_f32_32x32x16_bf16 v[176:191], v[212:215], v[80:83], v[176:191]
    ds_read_b128 v[204:207], v222 offset:46080
    s_add_u32 m0, s30, 49152
    s_add_u32 s11, s34, 262144
    buffer_load_dwordx4 v227, s[52:55], s11 offen lds
    v_fma_f32 v218, v218, v237, v237
    v_fma_f32 v219, v219, v237, v237
    v_rcp_f32 v216, v216
    v_rcp_f32 v217, v217
    s_waitcnt lgkmcnt(3)
    v_mfma_f32_32x32x16_bf16 v[176:191], v[192:195], v[88:91], v[176:191]
    ds_read_b128 v[208:211], v222 offset:48128
    v_rcp_f32 v218, v218
    v_rcp_f32 v219, v219
    v_mul_f32 v164, v164, v216
    v_mul_f32 v165, v165, v217
    v_mul_f32 v166, v166, v218
    s_waitcnt lgkmcnt(3)
    v_mfma_f32_32x32x16_bf16 v[176:191], v[196:199], v[96:99], v[176:191]
    s_add_u32 m0, s30, 90112
    s_add_u32 s11, s34, 278528
    buffer_load_dwordx4 v227, s[52:55], s11 offen lds
    v_mul_f32 v167, v167, v219
    v_cvt_pk_bf16_f32 v246, v164, v165
    v_cvt_pk_bf16_f32 v247, v166, v167
    buffer_store_dwordx4 v[244:247], v248, s[44:47], s82 offen sc1
    s_waitcnt lgkmcnt(2)
    v_mfma_f32_32x32x16_bf16 v[176:191], v[200:203], v[104:107], v[176:191]
    s_waitcnt lgkmcnt(1)
    v_mfma_f32_32x32x16_bf16 v[176:191], v[204:207], v[112:115], v[176:191]
    s_add_u32 m0, s30, 106496
    s_add_u32 s11, s34, 294912
    buffer_load_dwordx4 v227, s[52:55], s11 offen lds
    s_waitcnt lgkmcnt(0)
    v_mfma_f32_32x32x16_bf16 v[176:191], v[208:211], v[120:123], v[176:191]
    s_add_u32 m0, s30, 114688
    s_add_u32 s11, s34, 311296
    buffer_load_dwordx4 v227, s[52:55], s11 offen lds
    s_add_u32 s11, s17, 4096
    s_mov_b64 exec, 1
    buffer_load_dword v250, v252, s[44:47], s11 offen sc1
    s_mov_b64 exec, -1
    s_nop 4
    ds_write_b128 v238, v[176:179]
    ds_write_b128 v238, v[184:187] offset:1024
    s_waitcnt lgkmcnt(0)
    s_barrier
    ds_read_b128 v[176:179], v239
    ds_read_b128 v[184:187], v239 offset:1024
    s_waitcnt lgkmcnt(1)
    v_add_f32 v180, v180, v176
    v_add_f32 v181, v181, v177
    v_add_f32 v182, v182, v178
    v_add_f32 v183, v183, v179
    v_mul_f32 v216, v236, v180
    v_mul_f32 v217, v236, v181
    v_mul_f32 v218, v236, v182
    v_mul_f32 v219, v236, v183
    v_exp_f32 v216, v216
    v_exp_f32 v217, v217
    v_exp_f32 v218, v218
    v_exp_f32 v219, v219
    s_waitcnt lgkmcnt(0)
    v_add_f32 v188, v188, v184
    v_add_f32 v189, v189, v185
    v_add_f32 v190, v190, v186
    v_add_f32 v191, v191, v187
    v_fma_f32 v216, v216, v237, v237
    v_fma_f32 v217, v217, v237, v237
    v_fma_f32 v218, v218, v237, v237
    v_fma_f32 v219, v219, v237, v237
    v_rcp_f32 v216, v216
    v_rcp_f32 v217, v217
    v_rcp_f32 v218, v218
    v_rcp_f32 v219, v219
    v_mul_f32 v180, v180, v188
    v_mul_f32 v181, v181, v189
    v_mul_f32 v182, v182, v190
    v_mul_f32 v183, v183, v191
    v_mul_f32 v180, v180, v216
    v_mul_f32 v181, v181, v217
    v_mul_f32 v182, v182, v218
    v_mul_f32 v183, v183, v219
    v_cvt_pk_bf16_f32 v240, v180, v181
    v_cvt_pk_bf16_f32 v241, v182, v183
    s_nop 0
    v_permlane32_swap_b32 v240, v242
    v_permlane32_swap_b32 v241, v243
    s_mov_b32 exec_hi, 0
    buffer_store_dwordx4 v[240:243], v248, s[44:47], s79 offen sc1
    s_mov_b32 exec_hi, -1
L_g1_join:
    s_waitcnt vmcnt(1)
    v_readfirstlane_b32 s11, v250
    s_nop 0
    s_cmp_lt_u32 s11, 16
    s_cbranch_scc1 L_wg_7
L_okg_7:
    s_add_u32 s13, s22, 0
    buffer_load_dwordx4 v[128:131], v248, s[44:47], s13 offen offset:0 sc1
    buffer_load_dwordx4 v[132:135], v248, s[44:47], s13 offen offset:1024 sc1
    buffer_load_dwordx4 v[136:139], v248, s[44:47], s13 offen offset:2048 sc1
    buffer_load_dwordx4 v[140:143], v248, s[44:47], s13 offen offset:3072 sc1
    s_add_u32 s13, s22, 4096
    buffer_load_dwordx4 v[144:147], v248, s[44:47], s13 offen offset:0 sc1
    s_add_u32 s11, s30, 155648
    v_add_u32 v238, s11, v230
    ds_read_b64_tr_b16 v[208:209], v238
    ds_read_b64_tr_b16 v[210:211], v238 offset:256
    v_lshrrev_b32 v214, 5, v249
    v_bfe_u32 v212, v249, 3, 2
    v_and_b32 v213, 7, v249
    v_lshl_add_u32 v212, v213, 2, v212
    v_lshlrev_b32 v212, 10, v212
    v_lshl_add_u32 v239, v214, 4, v212
    v_and_b32 v215, 31, v249
    s_lshl_b32 s11, s10, 1
    v_add_u32 v216, s11, v214
    v_xor_b32 v216, v216, v213
    v_lshlrev_b32 v216, 4, v216
    v_lshl_add_u32 v215, v215, 7, v216
    s_lshl_b32 s11, s9, 12
    s_add_u32 s11, s11, 32768
    v_add_u32 v215, s11, v215
    v_lshrrev_b32 v217, 3, v249
    v_xor_b32 v216, v217, v213
    v_lshlrev_b32 v216, 4, v216
    v_lshl_add_u32 v216, v217, 7, v216
    s_lshl_b32 s12, s10, 10
    s_add_u32 s11, s11, s12
    v_add_u32 v216, s11, v216
    v_lshlrev_b32 v217, 12, v217
    v_lshl_add_u32 v217, v213, 4, v217
    s_mul_i32 s11, s10, 992
    s_add_u32 s26, s21, s11
    s_cmp_eq_u32 s3, 0
    s_cselect_b64 s[24:25], 1, 0
    s_mul_i32 s12, s9, 57344
    s_add_u32 s12, s12, 16384
    s_xor_b32 s11, s10, 1
    s_lshl_b32 s11, s11, 11
    s_add_u32 s11, s11, s12
    v_add_u32 v232, s11, v248
    s_lshl_b32 s11, s10, 11
    s_add_u32 s11, s11, s12
    v_add_u32 v235, s11, v248
    s_mul_i32 s12, s9, 57344
    s_add_u32 s12, s12, 24576
    s_xor_b32 s11, s10, 2
    s_lshl_b32 s11, s11, 11
    s_add_u32 s11, s11, s12
    v_add_u32 v233, s11, v248
    s_lshl_b32 s11, s10, 11
    s_add_u32 s11, s11, s12
    v_add_u32 v236, s11, v248
    s_mul_i32 s12, s9, 32768
    s_add_u32 s12, s12, 65536
    s_xor_b32 s11, s10, 3
    s_lshl_b32 s11, s11, 11
    s_add_u32 s11, s11, s12
    v_add_u32 v234, s11, v248
    s_lshl_b32 s11, s10, 11
    s_add_u32 s11, s11, s12
    v_add_u32 v237, s11, v248
    s_waitcnt vmcnt(5) lgkmcnt(0)
    s_barrier
    s_mov_b64 exec, s[24:25]
    buffer_atomic_add v253, v252, s[44:47], s16 offen sc1
    s_mov_b64 exec, -1
    buffer_load_dwordx4 v[148:151], v248, s[44:47], s13 offen offset:1024 sc1
    buffer_load_dwordx4 v[152:155], v248, s[44:47], s13 offen offset:2048 sc1
    buffer_load_dwordx4 v[156:159], v248, s[44:47], s13 offen offset:3072 sc1
    v_lshlrev_b32 v240, 16, v208
    v_and_b32 v241, 0xffff0000, v208
    v_lshlrev_b32 v242, 16, v209
    v_and_b32 v243, 0xffff0000, v209
    v_lshlrev_b32 v244, 16, v210
    v_and_b32 v245, 0xffff0000, v210
    v_lshlrev_b32 v246, 16, v211
    v_and_b32 v247, 0xffff0000, v211
    s_waitcnt vmcnt(7)
    s_setprio 3
    v_mfma_f32_32x32x16_bf16 v[176:191], v[4:7], v[128:131], 0
    s_add_u32 s13, s22, 8192
    buffer_load_dwordx4 v[160:163], v248, s[44:47], s13 offen offset:0 sc1
    v_mfma_f32_32x32x16_bf16 v[192:207], v[12:15], v[128:131], 0
    s_waitcnt vmcnt(7)
    v_mfma_f32_32x32x16_bf16 v[176:191], v[20:23], v[132:135], v[176:191]
    buffer_load_dwordx4 v[164:167], v248, s[44:47], s13 offen offset:1024 sc1
    v_mfma_f32_32x32x16_bf16 v[192:207], v[28:31], v[132:135], v[192:207]
    s_waitcnt vmcnt(7)
    v_mfma_f32_32x32x16_bf16 v[176:191], v[36:39], v[136:139], v[176:191]
    buffer_load_dwordx4 v[168:171], v248, s[44:47], s13 offen offset:2048 sc1
    v_mfma_f32_32x32x16_bf16 v[192:207], v[44:47], v[136:139], v[192:207]
    s_waitcnt vmcnt(7)
    v_mfma_f32_32x32x16_bf16 v[176:191], v[52:55], v[140:143], v[176:191]
    buffer_load_dwordx4 v[172:175], v248, s[44:47], s13 offen offset:3072 sc1
    v_mfma_f32_32x32x16_bf16 v[192:207], v[60:63], v[140:143], v[192:207]
    s_waitcnt vmcnt(7)
    s_setprio 2
    v_mfma_f32_32x32x16_bf16 v[176:191], v[68:71], v[144:147], v[176:191]
    s_add_u32 s13, s22, 12288
    buffer_load_dwordx4 v[0:3], v248, s[44:47], s13 offen offset:0 sc1
    v_mfma_f32_32x32x16_bf16 v[192:207], v[76:79], v[144:147], v[192:207]
    s_waitcnt vmcnt(7)
    v_mfma_f32_32x32x16_bf16 v[176:191], v[84:87], v[148:151], v[176:191]
    buffer_load_dwordx4 v[8:11], v248, s[44:47], s13 offen offset:1024 sc1
    v_mfma_f32_32x32x16_bf16 v[192:207], v[92:95], v[148:151], v[192:207]
    ds_read_b64_tr_b16 v[4:5], v223 offset:8192
    ds_read_b64_tr_b16 v[6:7], v223 offset:9216
    ds_read_b64_tr_b16 v[12:13], v225 offset:8192
    ds_read_b64_tr_b16 v[14:15], v225 offset:9216
    s_waitcnt vmcnt(7)
    v_mfma_f32_32x32x16_bf16 v[176:191], v[100:103], v[152:155], v[176:191]
    buffer_load_dwordx4 v[16:19], v248, s[44:47], s13 offen offset:2048 sc1
    v_mfma_f32_32x32x16_bf16 v[192:207], v[108:111], v[152:155], v[192:207]
    ds_read_b64_tr_b16 v[20:21], v223 offset:16384
    ds_read_b64_tr_b16 v[22:23], v223 offset:17408
    ds_read_b64_tr_b16 v[28:29], v225 offset:16384
    ds_read_b64_tr_b16 v[30:31], v225 offset:17408
    s_waitcnt vmcnt(7)
    v_mfma_f32_32x32x16_bf16 v[176:191], v[116:119], v[156:159], v[176:191]
    buffer_load_dwordx4 v[24:27], v248, s[44:47], s13 offen offset:3072 sc1
    s_add_u32 s11, s17, 0
    s_mov_b64 exec, 1
    buffer_load_dword v250, v252, s[44:47], s11 offen sc1
    s_mov_b64 exec, -1
    s_add_u32 m0, s30, 57344
    s_add_u32 s11, s34, 327680
    buffer_load_dwordx4 v227, s[52:55], s11 offen lds
    v_mfma_f32_32x32x16_bf16 v[192:207], v[124:127], v[156:159], v[192:207]
    s_add_u32 m0, s30, 122880
    s_add_u32 s11, s34, 344064
    buffer_load_dwordx4 v227, s[52:55], s11 offen lds
    ds_read_b64_tr_b16 v[36:37], v223 offset:24576
    ds_read_b64_tr_b16 v[38:39], v223 offset:25600
    ds_read_b64_tr_b16 v[44:45], v225 offset:24576
    ds_read_b64_tr_b16 v[46:47], v225 offset:25600
    s_waitcnt vmcnt(10) lgkmcnt(8)
    s_setprio 1
    v_mfma_f32_32x32x16_bf16 v[176:191], v[4:7], v[160:163], v[176:191]
    s_add_u32 m0, s30, 131072
    s_add_u32 s11, s34, 360448
    buffer_load_dwordx4 v227, s[52:55], s11 offen lds
    v_mfma_f32_32x32x16_bf16 v[192:207], v[12:15], v[160:163], v[192:207]
    s_add_u32 m0, s30, 139264
    s_add_u32 s11, s34, 376832
    buffer_load_dwordx4 v227, s[52:55], s11 offen lds
    ds_read_b64_tr_b16 v[52:53], v223 offset:40960
    ds_read_b64_tr_b16 v[54:55], v223 offset:41984
    ds_read_b64_tr_b16 v[60:61], v225 offset:40960
    ds_read_b64_tr_b16 v[62:63], v225 offset:41984
    s_waitcnt vmcnt(11) lgkmcnt(8)
    v_mfma_f32_32x32x16_bf16 v[176:191], v[20:23], v[164:167], v[176:191]
    s_add_u32 m0, s30, 147456
    s_add_u32 s11, s35, 393216
    buffer_load_dwordx4 v228, s[52:55], s11 offen lds
    v_mfma_f32_32x32x16_bf16 v[192:207], v[28:31], v[164:167], v[192:207]
    s_add_u32 m0, s30, 0
    s_add_u32 s11, s35, 409600
    buffer_load_dwordx4 v228, s[52:55], s11 offen lds
    ds_read_b64_tr_b16 v[68:69], v254 offset:16384
    ds_read_b64_tr_b16 v[70:71], v254 offset:17408
    ds_read_b64_tr_b16 v[76:77], v255 offset:16384
    ds_read_b64_tr_b16 v[78:79], v255 offset:17408
    s_waitcnt vmcnt(12) lgkmcnt(8)
    v_mfma_f32_32x32x16_bf16 v[176:191], v[36:39], v[168:171], v[176:191]
    s_add_u32 m0, s30, 8192
    s_add_u32 s11, s35, 425984
    buffer_load_dwordx4 v228, s[52:55], s11 offen lds
    v_mfma_f32_32x32x16_bf16 v[192:207], v[44:47], v[168:171], v[192:207]
    s_add_u32 m0, s30, 155648
    s_add_u32 s11, s35, 442368
    buffer_load_dwordx4 v228, s[52:55], s11 offen lds
    ds_read_b64_tr_b16 v[84:85], v254 offset:24576
    ds_read_b64_tr_b16 v[86:87], v254 offset:25600
    ds_read_b64_tr_b16 v[92:93], v255 offset:24576
    ds_read_b64_tr_b16 v[94:95], v255 offset:25600
    s_waitcnt vmcnt(8)
    v_readfirstlane_b32 s11, v250
    s_nop 0
    s_cmp_lt_u32 s11, 16
    s_cbranch_scc1 L_wg_8
L_okg_8:
    s_waitcnt lgkmcnt(8)
    v_mfma_f32_32x32x16_bf16 v[176:191], v[52:55], v[172:175], v[176:191]
    s_add_u32 s13, s23, 16384
    buffer_load_dwordx4 v[32:35], v248, s[44:47], s13 offen offset:0 sc1
    v_mfma_f32_32x32x16_bf16 v[192:207], v[60:63], v[172:175], v[192:207]
    buffer_load_dwordx4 v[40:43], v248, s[44:47], s13 offen offset:1024 sc1
    ds_read_b64_tr_b16 v[100:101], v254 offset:32768
    ds_read_b64_tr_b16 v[102:103], v254 offset:33792
    ds_read_b64_tr_b16 v[108:109], v255 offset:32768
    ds_read_b64_tr_b16 v[110:111], v255 offset:33792
    s_waitcnt lgkmcnt(8)
    s_setprio 0
    v_mfma_f32_32x32x16_bf16 v[176:191], v[68:71], v[0:3], v[176:191]
    buffer_load_dwordx4 v[48:51], v248, s[44:47], s13 offen offset:2048 sc1
    v_mfma_f32_32x32x16_bf16 v[192:207], v[76:79], v[0:3], v[192:207]
    buffer_load_dwordx4 v[56:59], v248, s[44:47], s13 offen offset:3072 sc1
    ds_read_b64_tr_b16 v[116:117], v254 offset:40960
    ds_read_b64_tr_b16 v[118:119], v254 offset:41984
    ds_read_b64_tr_b16 v[124:125], v255 offset:40960
    ds_read_b64_tr_b16 v[126:127], v255 offset:41984
    s_waitcnt lgkmcnt(8)
    v_mfma_f32_32x32x16_bf16 v[176:191], v[84:87], v[8:11], v[176:191]
    s_add_u32 s13, s23, 20480
    buffer_load_dwordx4 v[64:67], v248, s[44:47], s13 offen offset:0 sc1
    v_mfma_f32_32x32x16_bf16 v[192:207], v[92:95], v[8:11], v[192:207]
    buffer_load_dwordx4 v[72:75], v248, s[44:47], s13 offen offset:1024 sc1
    ds_read_b64_tr_b16 v[4:5], v254 offset:49152
    ds_read_b64_tr_b16 v[6:7], v254 offset:50176
    ds_read_b64_tr_b16 v[12:13], v255 offset:49152
    ds_read_b64_tr_b16 v[14:15], v255 offset:50176
    s_waitcnt lgkmcnt(8)
    v_mfma_f32_32x32x16_bf16 v[176:191], v[100:103], v[16:19], v[176:191]
    buffer_load_dwordx4 v[80:83], v248, s[44:47], s13 offen offset:2048 sc1
    v_mfma_f32_32x32x16_bf16 v[192:207], v[108:111], v[16:19], v[192:207]
    ds_read_b64_tr_b16 v[20:21], v223 offset:32768
    ds_read_b64_tr_b16 v[22:23], v223 offset:33792
    ds_read_b64_tr_b16 v[28:29], v225 offset:32768
    ds_read_b64_tr_b16 v[30:31], v225 offset:33792
    s_waitcnt lgkmcnt(8)
    v_mfma_f32_32x32x16_bf16 v[176:191], v[116:119], v[24:27], v[176:191]
    buffer_load_dwordx4 v[88:91], v248, s[44:47], s13 offen offset:3072 sc1
    v_mfma_f32_32x32x16_bf16 v[192:207], v[124:127], v[24:27], v[192:207]
    ds_read_b64_tr_b16 v[36:37], v224 offset:0
    ds_read_b64_tr_b16 v[38:39], v224 offset:1024
    ds_read_b64_tr_b16 v[44:45], v226 offset:0
    ds_read_b64_tr_b16 v[46:47], v226 offset:1024
    s_waitcnt vmcnt(7) lgkmcnt(8)
    s_barrier
    s_setprio 3
    v_mfma_f32_32x32x16_bf16 v[176:191], v[4:7], v[32:35], v[176:191]
    s_add_u32 s13, s74, 24576
    buffer_load_dwordx4 v[96:99], v248, s[44:47], s13 offen offset:0 sc1
    v_mfma_f32_32x32x16_bf16 v[192:207], v[12:15], v[32:35], v[192:207]
    ds_read_b64_tr_b16 v[52:53], v224 offset:8192
    ds_read_b64_tr_b16 v[54:55], v224 offset:9216
    ds_read_b64_tr_b16 v[60:61], v226 offset:8192
    ds_read_b64_tr_b16 v[62:63], v226 offset:9216
    s_waitcnt vmcnt(7) lgkmcnt(8)
    v_mfma_f32_32x32x16_bf16 v[176:191], v[20:23], v[40:43], v[176:191]
    buffer_load_dwordx4 v[104:107], v248, s[44:47], s13 offen offset:1024 sc1
    v_mfma_f32_32x32x16_bf16 v[192:207], v[28:31], v[40:43], v[192:207]
    ds_read_b64_tr_b16 v[68:69], v223 offset:0
    ds_read_b64_tr_b16 v[70:71], v223 offset:1024
    ds_read_b64_tr_b16 v[76:77], v225 offset:0
    ds_read_b64_tr_b16 v[78:79], v225 offset:1024
    s_waitcnt vmcnt(7) lgkmcnt(8)
    v_mfma_f32_32x32x16_bf16 v[176:191], v[36:39], v[48:51], v[176:191]
    buffer_load_dwordx4 v[112:115], v248, s[44:47], s13 offen offset:2048 sc1
    v_mfma_f32_32x32x16_bf16 v[192:207], v[44:47], v[48:51], v[192:207]
    ds_read_b64_tr_b16 v[84:85], v224 offset:16384
    ds_read_b64_tr_b16 v[86:87], v224 offset:17408
    ds_read_b64_tr_b16 v[92:93], v226 offset:16384
    ds_read_b64_tr_b16 v[94:95], v226 offset:17408
    s_waitcnt vmcnt(7) lgkmcnt(8)
    s_setprio 2
    v_mfma_f32_32x32x16_bf16 v[176:191], v[52:55], v[56:59], v[176:191]
    buffer_load_dwordx4 v[120:123], v248, s[44:47], s13 offen offset:3072 sc1
    v_mfma_f32_32x32x16_bf16 v[192:207], v[60:63], v[56:59], v[192:207]
    ds_read_b64_tr_b16 v[100:101], v224 offset:24576
    ds_read_b64_tr_b16 v[102:103], v224 offset:25600
    ds_read_b64_tr_b16 v[108:109], v226 offset:24576
    ds_read_b64_tr_b16 v[110:111], v226 offset:25600
    s_waitcnt vmcnt(7) lgkmcnt(8)
    v_mfma_f32_32x32x16_bf16 v[176:191], v[68:71], v[64:67], v[176:191]
    v_mfma_f32_32x32x16_bf16 v[192:207], v[76:79], v[64:67], v[192:207]
    ds_read_b64_tr_b16 v[116:117], v224 offset:32768
    ds_read_b64_tr_b16 v[118:119], v224 offset:33792
    ds_read_b64_tr_b16 v[124:125], v226 offset:32768
    ds_read_b64_tr_b16 v[126:127], v226 offset:33792
    s_waitcnt vmcnt(6) lgkmcnt(8)
    v_mfma_f32_32x32x16_bf16 v[176:191], v[84:87], v[72:75], v[176:191]
    v_mfma_f32_32x32x16_bf16 v[192:207], v[92:95], v[72:75], v[192:207]
    ds_read_b64_tr_b16 v[4:5], v224 offset:40960
    ds_read_b64_tr_b16 v[6:7], v224 offset:41984
    ds_read_b64_tr_b16 v[12:13], v226 offset:40960
    ds_read_b64_tr_b16 v[14:15], v226 offset:41984
    s_waitcnt vmcnt(5) lgkmcnt(8)
    s_setprio 1
    v_mfma_f32_32x32x16_bf16 v[176:191], v[100:103], v[80:83], v[176:191]
    v_mfma_f32_32x32x16_bf16 v[192:207], v[108:111], v[80:83], v[192:207]
    ds_read_b64_tr_b16 v[20:21], v254 offset:0
    ds_read_b64_tr_b16 v[22:23], v254 offset:1024
    ds_read_b64_tr_b16 v[28:29], v255 offset:0
    ds_read_b64_tr_b16 v[30:31], v255 offset:1024
    s_waitcnt vmcnt(4) lgkmcnt(8)
    v_mfma_f32_32x32x16_bf16 v[192:207], v[124:127], v[88:91], v[192:207]
    ds_read_b64_tr_b16 v[36:37], v254 offset:8192
    ds_read_b64_tr_b16 v[38:39], v254 offset:9216
    ds_read_b64_tr_b16 v[44:45], v255 offset:8192
    ds_read_b64_tr_b16 v[46:47], v255 offset:9216
    s_waitcnt vmcnt(3) lgkmcnt(8)
    v_mfma_f32_32x32x16_bf16 v[192:207], v[12:15], v[96:99], v[192:207]
    ds_read_b64_tr_b16 v[52:53], v224 offset:49152
    ds_read_b64_tr_b16 v[54:55], v224 offset:50176
    ds_read_b64_tr_b16 v[60:61], v226 offset:49152
    ds_read_b64_tr_b16 v[62:63], v226 offset:50176
    s_waitcnt vmcnt(2) lgkmcnt(8)
    v_mfma_f32_32x32x16_bf16 v[192:207], v[28:31], v[104:107], v[192:207]
    s_waitcnt vmcnt(1) lgkmcnt(4)
    v_mfma_f32_32x32x16_bf16 v[192:207], v[44:47], v[112:115], v[192:207]
    s_waitcnt vmcnt(0) lgkmcnt(0)
    v_mfma_f32_32x32x16_bf16 v[192:207], v[60:63], v[120:123], v[192:207]
    v_mfma_f32_32x32x16_bf16 v[176:191], v[116:119], v[88:91], v[176:191]
    v_mfma_f32_32x32x16_bf16 v[176:191], v[4:7], v[96:99], v[176:191]
    s_nop 7
    s_nop 1
    ds_write_b128 v233, v[192:195] offset:0
    v_mfma_f32_32x32x16_bf16 v[176:191], v[20:23], v[104:107], v[176:191]
    ds_write_b128 v233, v[196:199] offset:1024
    v_mfma_f32_32x32x16_bf16 v[176:191], v[36:39], v[112:115], v[176:191]
    ds_write_b128 v234, v[200:203] offset:0
    v_mfma_f32_32x32x16_bf16 v[176:191], v[52:55], v[120:123], v[176:191]
    ds_write_b128 v234, v[204:207] offset:1024
    s_nop 10
    ds_write_b128 v232, v[184:187] offset:0
    ds_write_b128 v232, v[188:191] offset:1024
    s_waitcnt lgkmcnt(0)
    s_barrier
    ds_read_b128 v[32:35], v235
    ds_read_b128 v[36:39], v235 offset:1024
    ds_read_b128 v[40:43], v236
    ds_read_b128 v[44:47], v236 offset:1024
    ds_read_b128 v[48:51], v237
    ds_read_b128 v[52:55], v237 offset:1024
    s_waitcnt lgkmcnt(4)
    v_add_f32 v176, v176, v32
    v_add_f32 v177, v177, v33
    v_add_f32 v178, v178, v34
    v_add_f32 v179, v179, v35
    v_add_f32 v180, v180, v36
    v_add_f32 v181, v181, v37
    v_add_f32 v182, v182, v38
    v_add_f32 v183, v183, v39
    s_waitcnt lgkmcnt(2)
    v_add_f32 v176, v176, v40
    v_add_f32 v177, v177, v41
    v_add_f32 v178, v178, v42
    v_add_f32 v179, v179, v43
    v_add_f32 v180, v180, v44
    v_add_f32 v181, v181, v45
    v_add_f32 v182, v182, v46
    v_add_f32 v183, v183, v47
    s_waitcnt lgkmcnt(0)
    v_add_f32 v176, v176, v48
    v_add_f32 v177, v177, v49
    v_add_f32 v178, v178, v50
    v_add_f32 v179, v179, v51
    v_add_f32 v180, v180, v52
    v_add_f32 v181, v181, v53
    v_add_f32 v182, v182, v54
    v_add_f32 v183, v183, v55
    v_cvt_pk_bf16_f32 v8, v176, v177
    v_cvt_pk_bf16_f32 v9, v178, v179
    v_cvt_pk_bf16_f32 v10, v180, v181
    v_cvt_pk_bf16_f32 v11, v182, v183
    v_dot2c_f32_bf16 v240, s80, v8
    v_dot2c_f32_bf16 v241, s81, v8
    v_dot2c_f32_bf16 v242, s80, v9
    v_dot2c_f32_bf16 v243, s81, v9
    v_dot2c_f32_bf16 v244, s80, v10
    v_dot2c_f32_bf16 v245, s81, v10
    v_dot2c_f32_bf16 v246, s80, v11
    v_dot2c_f32_bf16 v247, s81, v11
    v_cvt_pk_bf16_f32 v8, v240, v241
    v_cvt_pk_bf16_f32 v9, v242, v243
    v_cvt_pk_bf16_f32 v10, v244, v245
    v_cvt_pk_bf16_f32 v11, v246, v247
    ds_write_b128 v215, v[8:11]
    s_waitcnt lgkmcnt(0)
    s_barrier
    ds_read_b128 v[8:11], v216
    s_waitcnt lgkmcnt(0)
    buffer_store_dwordx4 v[8:11], v217, s[56:59], s26 offen
L_end:
    s_endpgm
L_notready2:
    s_mov_b32 s12, 0
    v_lshlrev_b32 v29, 2, v42
L_nr_loop2:
    global_load_dword v47, v29, s[40:41] sc1
    s_add_u32 s12, s12, 1
    s_waitcnt vmcnt(0)
    v_cmp_ne_u32 vcc, 0x01010101, v47
    s_cmp_gt_u32 s12, 1000000
    s_cbranch_scc1 L_ready2
    s_cbranch_vccnz L_nr_loop2
    s_branch L_ready2
L_stwait0:
    s_mov_b32 s12, 0
L_stloop0:
    buffer_load_dword v184, v235, s[44:47], s38 offen offset:0 sc1
    buffer_load_dword v185, v235, s[44:47], s38 offen offset:256 sc1
    buffer_load_dword v186, v235, s[44:47], s38 offen offset:512 sc1
    buffer_load_dword v187, v235, s[44:47], s38 offen offset:768 sc1
    s_add_u32 s12, s12, 1
    s_waitcnt vmcnt(0)
    v_and_b32 v188, v184, v185
    v_and_b32 v189, v186, v187
    v_and_b32 v188, v188, v189
    v_and_b32 v188, 1, v188
    v_cmp_eq_u32 vcc, 0, v188
    s_cmp_gt_u32 s12, 1000000
    s_cbranch_scc1 L_stok0
    s_cbranch_vccnz L_stloop0
    s_branch L_stok0
L_stwait1:
    s_mov_b32 s12, 0
L_stloop1:
    buffer_load_dword v184, v235, s[44:47], s38 offen offset:0 sc1
    buffer_load_dword v185, v235, s[44:47], s38 offen offset:256 sc1
    buffer_load_dword v186, v235, s[44:47], s38 offen offset:512 sc1
    buffer_load_dword v187, v235, s[44:47], s38 offen offset:768 sc1
    s_add_u32 s12, s12, 1
    s_waitcnt vmcnt(0)
    v_and_b32 v188, v184, v185
    v_and_b32 v189, v186, v187
    v_and_b32 v188, v188, v189
    v_and_b32 v188, 1, v188
    v_cmp_eq_u32 vcc, 0, v188
    s_cmp_gt_u32 s12, 1000000
    s_cbranch_scc1 L_stok1
    s_cbranch_vccnz L_stloop1
    s_branch L_stok1
L_wg_7:
    s_mov_b32 s12, 0
L_lg_7:
    s_sleep 6
    s_add_u32 s11, s17, 4096
    s_mov_b64 exec, 1
    buffer_load_dword v250, v252, s[44:47], s11 offen sc1
    s_mov_b64 exec, -1
    s_add_u32 s12, s12, 1
    s_waitcnt vmcnt(0)
    v_readfirstlane_b32 s11, v250
    s_cmp_gt_u32 s12, 1000000
    s_cbranch_scc1 L_okg_7
    s_cmp_lt_u32 s11, 16
    s_cbranch_scc1 L_lg_7
    s_branch L_okg_7
L_wg_8:
    s_mov_b32 s12, 0
L_lg_8:
    s_sleep 6
    s_add_u32 s11, s17, 0
    s_mov_b64 exec, 1
    buffer_load_dword v250, v252, s[44:47], s11 offen sc1
    s_mov_b64 exec, -1
    s_add_u32 s12, s12, 1
    s_waitcnt vmcnt(0)
    v_readfirstlane_b32 s11, v250
    s_cmp_gt_u32 s12, 1000000
    s_cbranch_scc1 L_okg_8
    s_cmp_lt_u32 s11, 16
    s_cbranch_scc1 L_lg_8
    s_branch L_okg_8
.p2align 4
.type L_gtab,@object
L_gtab:
.short 0,2,4,6,128,130,132,134,8,10,12,14,136,138,140,142
.short 16,18,20,22,144,146,148,150,24,26,28,30,152,154,156,158
.short 32,34,36,38,160,162,164,166,40,42,44,46,168,170,172,174
.short 48,50,52,54,176,178,180,182,56,58,60,62,184,186,188,190
.short 64,66,68,70,192,194,196,198,72,74,76,78,200,202,204,206
.short 80,82,84,86,208,210,212,214,88,90,92,94,216,218,220,222
.short 96,98,100,102,224,226,228,230,104,106,108,110,232,234,236,238
.short 112,114,116,118,240,242,244,246,120,122,124,126,248,250,252,254
.short 256,258,260,262,384,386,388,390,264,266,268,270,392,394,396,398
.short 272,274,276,278,400,402,404,406,280,282,284,286,408,410,412,414
.short 288,290,292,294,416,418,420,422,296,298,300,302,424,426,428,430
.short 304,306,308,310,432,434,436,438,312,314,316,318,440,442,444,446
.short 320,322,324,326,448,450,452,454,328,330,332,334,456,458,460,462
.short 336,338,340,342,464,466,468,470,344,346,348,350,472,474,476,478
.short 352,354,356,358,480,482,484,486,360,362,364,366,488,490,492,494
.short 368,370,372,374,496,498,500,502,376,378,380,382,504,506,508,510
.short 512,512,514,516,516,516,518,520,520,520,522,524,524,524,526,528
.short 528,528,530,532,532,532,534,536,536,536,538,540,540,540,542,544
.short 544,544,546,548,548,548,550,552,552,552,554,556,556,556,558,560
.short 560,560,562,564,564,564,566,568,568,568,570,572,572,572,574,576
.short 576,576,578,580,580,580,582,584,584,584,586,588,588,588,590,592
.short 592,592,594,596,596,596,598,600,600,600,602,604,604,604,606,608
.short 608,608,610,612,612,612,614,616,616,616,618,620,620,620,622,624
.short 624,624,626,628,628,628,630,632,632,632,634,636,636,636,638,640
.short 640,640,642,644,644,644,646,648,648,648,650,652,652,652,654,656
.short 656,656,658,660,660,660,662,664,664,664,666,668,668,668,670,672
.short 672,672,674,676,676,676,678,680,680,680,682,684,684,684,686,688
.short 688,688,690,692,692,692,694,696,696,696,698,700,700,700,702,704
.short 704,704,706,708,708,708,710,712,712,712,714,716,716,716,718,720
.short 720,720,722,724,724,724,726,728,728,728,730,732,732,732,734,736
.short 736,736,738,740,740,740,742,744,744,744,746,748,748,748,750,752
.short 752,752,754,756,756,756,758,760,760,760,762,764,764,764,766,768
.short 768,768,768,770,770,770,776,776,776,776,776,778,778,778,784,784
.short 784,784,784,786,786,786,792,792,792,792,792,794,794,794,800,800
.short 800,800,800,802,802,802,808,808,808,808,808,810,810,810,816,816
.short 816,816,816,818,818,818,824,824,824,824,824,826,826,826,832,832
.short 832,832,832,834,834,834,840,840,840,840,840,842,842,842,848,848
.short 848,848,848,850,850,850,856,856,856,856,856,858,858,858,864,864
.short 864,864,864,866,866,866,872,872,872,872,872,874,874,874,880,880
.short 880,880,880,882,882,882,888,888,888,888,888,890,890,890,772,772
.short 772,772,772,774,774,774,780,780,780,780,780,782,782,782,788,788
.short 788,788,788,790,790,790,796,796,796,796,796,798,798,798,804,804
.short 804,804,804,806,806,806,812,812,812,812,812,814,814,814,820,820
.short 820,820,820,822,822,822,828,828,828,828,828,830,830,830,836,836
.short 836,836,836,838,838,838,844,844,844,844,844,846,846,846,852,852
.short 852,852,852,854,854,854,860,860,860,860,860,862,862,862,868,868
.short 868,868,868,870,870,870,876,876,876,876,876,878,878,878,884,884
.short 884,884,884,886,886,886,892,892,892,892,892,894,894,894,896,896
.short 896,896,896,898,898,898,904,904,904,904,904,906,906,906,912,912
.short 912,912,912,914,914,914,920,920,920,920,920,922,922,922,928,928
.short 928,928,928,930,930,930,936,936,936,936,936,938,938,938,944,944
.short 944,944,944,946,946,946,952,952,952,952,952,954,954,954,960,960
.short 960,960,960,962,962,962,968,968,968,968,968,970,970,970,976,976
.short 976,976,976,978,978,978,984,984,984,984,984,986,986,986,992,992
.short 992,992,992,994,994,994,1000,1000,1000,1000,1000,1002,1002,1002,1008,1008
.short 1008,1008,1008,1010,1010,1010,1016,1016,1016,1016,1016,1018,1018,1018,900,900
.short 900,900,900,902,902,902,908,908,908,908,908,910,910,910,916,916
.short 916,916,916,918,918,918,924,924,924,924,924,926,926,926,932,932
.short 932,932,932,934,934,934,940,940,940,940,940,942,942,942,948,948
.short 948,948,948,950,950,950,956,956,956,956,956,958,958,958,964,964
.short 964,964,964,966,966,966,972,972,972,972,972,974,974,974,980,980
.short 980,980,980,982,982,982,988,988,988,988,988,990,990,990,996,996
.short 996,996,996,998,998,998,1004,1004,1004,1004,1004,1006,1006,1006,1012,1012
.short 1012,1012,1012,1014,1014,1014,1020,1020,1020,1020,1020,1022,1022,1022,1024,1024
.short 1024,1024,1024,1024,1024,1032,1032,1032,1032,1032,1032,1032,1040,1040,1040,1040
.short 1040,1040,1040,1040,1040,1048,1048,1048,1048,1048,1048,1048,1056,1056,1056,1056
.short 1056,1056,1056,1056,1056,1064,1064,1064,1064,1064,1064,1064,1072,1072,1072,1072
.short 1072,1072,1072,1072,1072,1080,1080,1080,1080,1080,1080,1080,1088,1088,1088,1088
.short 1088,1088,1088,1088,1088,1096,1096,1096,1096,1096,1096,1096,1104,1104,1104,1104
.short 1104,1104,1104,1104,1104,1112,1112,1112,1112,1112,1112,1112,1120,1120,1120,1120
.short 1120,1120,1120,1120,1120,1128,1128,1128,1128,1128,1128,1128,1136,1136,1136,1136
.short 1136,1136,1136,1136,1136,1144,1144,1144,1144,1144,1144,1144,1026,1026,1026,1026
.short 1026,1026,1026,1026,1026,1034,1034,1034,1034,1034,1034,1034,1042,1042,1042,1042
.short 1042,1042,1042,1042,1042,1050,1050,1050,1050,1050,1050,1050,1058,1058,1058,1058
.short 1058,1058,1058,1058,1058,1066,1066,1066,1066,1066,1066,1066,1074,1074,1074,1074
.short 1074,1074,1074,1074,1074,1082,1082,1082,1082,1082,1082,1082,1090,1090,1090,1090
.short 1090,1090,1090,1090,1090,1098,1098,1098,1098,1098,1098,1098,1106,1106,1106,1106
.short 1106,1106,1106,1106,1106,1114,1114,1114,1114,1114,1114,1114,1122,1122,1122,1122
.short 1122,1122,1122,1122,1122,1130,1130,1130,1130,1130,1130,1130,1138,1138,1138,1138
.short 1138,1138,1138,1138,1138,1146,1146,1146,1146,1146,1146,1146,1028,1028,1028,1028
.short 1028,1028,1028,1028,1028,1036,1036,1036,1036,1036,1036,1036,1044,1044,1044,1044
.short 1044,1044,1044,1044,1044,1052,1052,1052,1052,1052,1052,1052,1060,1060,1060,1060
.short 1060,1060,1060,1060,1060,1068,1068,1068,1068,1068,1068,1068,1076,1076,1076,1076
.short 1076,1076,1076,1076,1076,1084,1084,1084,1084,1084,1084,1084,1092,1092,1092,1092
.short 1092,1092,1092,1092,1092,1100,1100,1100,1100,1100,1100,1100,1108,1108,1108,1108
.short 1108,1108,1108,1108,1108,1116,1116,1116,1116,1116,1116,1116,1124,1124,1124,1124
.short 1124,1124,1124,1124,1124,1132,1132,1132,1132,1132,1132,1132,1140,1140,1140,1140
.short 1140,1140,1140,1140,1140,1148,1148,1148,1148,1148,1148,1148,1030,1030,1030,1030
.short 1030,1030,1030,1030,1030,1038,1038,1038,1038,1038,1038,1038,1046,1046,1046,1046
.short 1046,1046,1046,1046,1046,1054,1054,1054,1054,1054,1054,1054,1062,1062,1062,1062
.short 1062,1062,1062,1062,1062,1070,1070,1070,1070,1070,1070,1070,1078,1078,1078,1078
.short 1078,1078,1078,1078,1078,1086,1086,1086,1086,1086,1086,1086,1094,1094,1094,1094
.short 1094,1094,1094,1094,1094,1102,1102,1102,1102,1102,1102,1102,1110,1110,1110,1110
.short 1110,1110,1110,1110,1110,1118,1118,1118,1118,1118,1118,1118,1126,1126,1126,1126
.short 1126,1126,1126,1126,1126,1134,1134,1134,1134,1134,1134,1134,1142,1142,1142,1142
.short 1142,1142,1142,1142,1142,1150,1150,1150,1150,1150,1150,1150,1152,1152,1152,1152
.short 1152,1152,1152,1152,1152,1160,1160,1160,1160,1160,1160,1160,1168,1168,1168,1168
.short 1168,1168,1168,1168,1168,1176,1176,1176,1176,1176,1176,1176,1184,1184,1184,1184
.short 1184,1184,1184,1184,1184,1192,1192,1192,1192,1192,1192,1192,1200,1200,1200,1200
.short 1200,1200,1200,1200,1200,1208,1208,1208,1208,1208,1208,1208,1216,1216,1216,1216
.short 1216,1216,1216,1216,1216,1224,1224,1224,1224,1224,1224,1224,1232,1232,1232,1232
.short 1232,1232,1232,1232,1232,1240,1240,1240,1240,1240,1240,1240,1248,1248,1248,1248
.short 1248,1248,1248,1248,1248,1256,1256,1256,1256,1256,1256,1256,1264,1264,1264,1264
.short 1264,1264,1264,1264,1264,1272,1272,1272,1272,1272,1272,1272,1154,1154,1154,1154
.short 1154,1154,1154,1154,1154,1162,1162,1162,1162,1162,1162,1162,1170,1170,1170,1170
.short 1170,1170,1170,1170,1170,1178,1178,1178,1178,1178,1178,1178,1186,1186,1186,1186
.short 1186,1186,1186,1186,1186,1194,1194,1194,1194,1194,1194,1194,1202,1202,1202,1202
.short 1202,1202,1202,1202,1202,1210,1210,1210,1210,1210,1210,1210,1218,1218,1218,1218
.short 1218,1218,1218,1218,1218,1226,1226,1226,1226,1226,1226,1226,1234,1234,1234,1234
.short 1234,1234,1234,1234,1234,1242,1242,1242,1242,1242,1242,1242,1250,1250,1250,1250
.short 1250,1250,1250,1250,1250,1258,1258,1258,1258,1258,1258,1258,1266,1266,1266,1266
.short 1266,1266,1266,1266,1266,1274,1274,1274,1274,1274,1274,1274,1156,1156,1156,1156
.short 1156,1156,1156,1156,1156,1164,1164,1164,1164,1164,1164,1164,1172,1172,1172,1172
.short 1172,1172,1172,1172,1172,1180,1180,1180,1180,1180,1180,1180,1188,1188,1188,1188
.short 1188,1188,1188,1188,1188,1196,1196,1196,1196,1196,1196,1196,1204,1204,1204,1204
.short 1204,1204,1204,1204,1204,1212,1212,1212,1212,1212,1212,1212,1220,1220,1220,1220
.short 1220,1220,1220,1220,1220,1228,1228,1228,1228,1228,1228,1228,1236,1236,1236,1236
.short 1236,1236,1236,1236,1236,1244,1244,1244,1244,1244,1244,1244,1252,1252,1252,1252
.short 1252,1252,1252,1252,1252,1260,1260,1260,1260,1260,1260,1260,1268,1268,1268,1268
.short 1268,1268,1268,1268,1268,1276,1276,1276,1276,1276,1276,1276,1158,1158,1158,1158
.short 1158,1158,1158,1158,1158,1166,1166,1166,1166,1166,1166,1166,1174,1174,1174,1174
.short 1174,1174,1174,1174,1174,1182,1182,1182,1182,1182,1182,1182,1190,1190,1190,1190
.short 1190,1190,1190,1190,1190,1198,1198,1198,1198,1198,1198,1198,1206,1206,1206,1206
.short 1206,1206,1206,1206,1206,1214,1214,1214,1214,1214,1214,1214,1222,1222,1222,1222
.short 1222,1222,1222,1222,1222,1230,1230,1230,1230,1230,1230,1230,1238,1238,1238,1238
.short 1238,1238,1238,1238,1238,1246,1246,1246,1246,1246,1246,1246,1254,1254,1254,1254
.short 1254,1254,1254,1254,1254,1262,1262,1262,1262,1262,1262,1262,1270,1270,1270,1270
.short 1270,1270,1270,1270,1270,1278,1278,1278,1278,1278,1278,1278,1280,1280,1280,1280
.short 2048,2050,2052,2054,2176,2178,2180,2182,2056,2058,2060,2062,2184,2186,2188,2190
.short 2064,2066,2068,2070,2192,2194,2196,2198,2072,2074,2076,2078,2200,2202,2204,2206
.short 2080,2082,2084,2086,2208,2210,2212,2214,2088,2090,2092,2094,2216,2218,2220,2222
.short 2096,2098,2100,2102,2224,2226,2228,2230,2104,2106,2108,2110,2232,2234,2236,2238
.short 2112,2114,2116,2118,2240,2242,2244,2246,2120,2122,2124,2126,2248,2250,2252,2254
.short 2128,2130,2132,2134,2256,2258,2260,2262,2136,2138,2140,2142,2264,2266,2268,2270
.short 2144,2146,2148,2150,2272,2274,2276,2278,2152,2154,2156,2158,2280,2282,2284,2286
.short 2160,2162,2164,2166,2288,2290,2292,2294,2168,2170,2172,2174,2296,2298,2300,2302
.short 2304,2306,2308,2310,2432,2434,2436,2438,2312,2314,2316,2318,2440,2442,2444,2446
.short 2320,2322,2324,2326,2448,2450,2452,2454,2328,2330,2332,2334,2456,2458,2460,2462
.short 2336,2338,2340,2342,2464,2466,2468,2470,2344,2346,2348,2350,2472,2474,2476,2478
.short 2352,2354,2356,2358,2480,2482,2484,2486,2360,2362,2364,2366,2488,2490,2492,2494
.short 2368,2370,2372,2374,2496,2498,2500,2502,2376,2378,2380,2382,2504,2506,2508,2510
.short 2384,2386,2388,2390,2512,2514,2516,2518,2392,2394,2396,2398,2520,2522,2524,2526
.short 2400,2402,2404,2406,2528,2530,2532,2534,2408,2410,2412,2414,2536,2538,2540,2542
.short 2416,2418,2420,2422,2544,2546,2548,2550,2424,2426,2428,2430,2552,2554,2556,2558
.short 2560,2560,2562,2564,2564,2564,2566,2568,2568,2568,2570,2572,2572,2572,2574,2576
.short 2576,2576,2578,2580,2580,2580,2582,2584,2584,2584,2586,2588,2588,2588,2590,2592
.short 2592,2592,2594,2596,2596,2596,2598,2600,2600,2600,2602,2604,2604,2604,2606,2608
.short 2608,2608,2610,2612,2612,2612,2614,2616,2616,2616,2618,2620,2620,2620,2622,2624
.short 2624,2624,2626,2628,2628,2628,2630,2632,2632,2632,2634,2636,2636,2636,2638,2640
.short 2640,2640,2642,2644,2644,2644,2646,2648,2648,2648,2650,2652,2652,2652,2654,2656
.short 2656,2656,2658,2660,2660,2660,2662,2664,2664,2664,2666,2668,2668,2668,2670,2672
.short 2672,2672,2674,2676,2676,2676,2678,2680,2680,2680,2682,2684,2684,2684,2686,2688
.short 2688,2688,2690,2692,2692,2692,2694,2696,2696,2696,2698,2700,2700,2700,2702,2704
.short 2704,2704,2706,2708,2708,2708,2710,2712,2712,2712,2714,2716,2716,2716,2718,2720
.short 2720,2720,2722,2724,2724,2724,2726,2728,2728,2728,2730,2732,2732,2732,2734,2736
.short 2736,2736,2738,2740,2740,2740,2742,2744,2744,2744,2746,2748,2748,2748,2750,2752
.short 2752,2752,2754,2756,2756,2756,2758,2760,2760,2760,2762,2764,2764,2764,2766,2768
.short 2768,2768,2770,2772,2772,2772,2774,2776,2776,2776,2778,2780,2780,2780,2782,2784
.short 2784,2784,2786,2788,2788,2788,2790,2792,2792,2792,2794,2796,2796,2796,2798,2800
.short 2800,2800,2802,2804,2804,2804,2806,2808,2808,2808,2810,2812,2812,2812,2814,2816
.short 2816,2816,2816,2818,2818,2818,2824,2824,2824,2824,2824,2826,2826,2826,2832,2832
.short 2832,2832,2832,2834,2834,2834,2840,2840,2840,2840,2840,2842,2842,2842,2848,2848
.short 2848,2848,2848,2850,2850,2850,2856,2856,2856,2856,2856,2858,2858,2858,2864,2864
.short 2864,2864,2864,2866,2866,2866,2872,2872,2872,2872,2872,2874,2874,2874,2880,2880
.short 2880,2880,2880,2882,2882,2882,2888,2888,2888,2888,2888,2890,2890,2890,2896,2896
.short 2896,2896,2896,2898,2898,2898,2904,2904,2904,2904,2904,2906,2906,2906,2912,2912
.short 2912,2912,2912,2914,2914,2914,2920,2920,2920,2920,2920,2922,2922,2922,2928,2928
.short 2928,2928,2928,2930,2930,2930,2936,2936,2936,2936,2936,2938,2938,2938,2820,2820
.short 2820,2820,2820,2822,2822,2822,2828,2828,2828,2828,2828,2830,2830,2830,2836,2836
.short 2836,2836,2836,2838,2838,2838,2844,2844,2844,2844,2844,2846,2846,2846,2852,2852
.short 2852,2852,2852,2854,2854,2854,2860,2860,2860,2860,2860,2862,2862,2862,2868,2868
.short 2868,2868,2868,2870,2870,2870,2876,2876,2876,2876,2876,2878,2878,2878,2884,2884
.short 2884,2884,2884,2886,2886,2886,2892,2892,2892,2892,2892,2894,2894,2894,2900,2900
.short 2900,2900,2900,2902,2902,2902,2908,2908,2908,2908,2908,2910,2910,2910,2916,2916
.short 2916,2916,2916,2918,2918,2918,2924,2924,2924,2924,2924,2926,2926,2926,2932,2932
.short 2932,2932,2932,2934,2934,2934,2940,2940,2940,2940,2940,2942,2942,2942,2944,2944
.short 2944,2944,2944,2946,2946,2946,2952,2952,2952,2952,2952,2954,2954,2954,2960,2960
.short 2960,2960,2960,2962,2962,2962,2968,2968,2968,2968,2968,2970,2970,2970,2976,2976
.short 2976,2976,2976,2978,2978,2978,2984,2984,2984,2984,2984,2986,2986,2986,2992,2992
.short 2992,2992,2992,2994,2994,2994,3000,3000,3000,3000,3000,3002,3002,3002,3008,3008
.short 3008,3008,3008,3010,3010,3010,3016,3016,3016,3016,3016,3018,3018,3018,3024,3024
.short 3024,3024,3024,3026,3026,3026,3032,3032,3032,3032,3032,3034,3034,3034,3040,3040
.short 3040,3040,3040,3042,3042,3042,3048,3048,3048,3048,3048,3050,3050,3050,3056,3056
.short 3056,3056,3056,3058,3058,3058,3064,3064,3064,3064,3064,3066,3066,3066,2948,2948
.short 2948,2948,2948,2950,2950,2950,2956,2956,2956,2956,2956,2958,2958,2958,2964,2964
.short 2964,2964,2964,2966,2966,2966,2972,2972,2972,2972,2972,2974,2974,2974,2980,2980
.short 2980,2980,2980,2982,2982,2982,2988,2988,2988,2988,2988,2990,2990,2990,2996,2996
.short 2996,2996,2996,2998,2998,2998,3004,3004,3004,3004,3004,3006,3006,3006,3012,3012
.short 3012,3012,3012,3014,3014,3014,3020,3020,3020,3020,3020,3022,3022,3022,3028,3028
.short 3028,3028,3028,3030,3030,3030,3036,3036,3036,3036,3036,3038,3038,3038,3044,3044
.short 3044,3044,3044,3046,3046,3046,3052,3052,3052,3052,3052,3054,3054,3054,3060,3060
.short 3060,3060,3060,3062,3062,3062,3068,3068,3068,3068,3068,3070,3070,3070,3072,3072
.short 3072,3072,3072,3072,3072,3080,3080,3080,3080,3080,3080,3080,3088,3088,3088,3088
.short 3088,3088,3088,3088,3088,3096,3096,3096,3096,3096,3096,3096,3104,3104,3104,3104
.short 3104,3104,3104,3104,3104,3112,3112,3112,3112,3112,3112,3112,3120,3120,3120,3120
.short 3120,3120,3120,3120,3120,3128,3128,3128,3128,3128,3128,3128,3136,3136,3136,3136
.short 3136,3136,3136,3136,3136,3144,3144,3144,3144,3144,3144,3144,3152,3152,3152,3152
.short 3152,3152,3152,3152,3152,3160,3160,3160,3160,3160,3160,3160,3168,3168,3168,3168
.short 3168,3168,3168,3168,3168,3176,3176,3176,3176,3176,3176,3176,3184,3184,3184,3184
.short 3184,3184,3184,3184,3184,3192,3192,3192,3192,3192,3192,3192,3074,3074,3074,3074
.short 3074,3074,3074,3074,3074,3082,3082,3082,3082,3082,3082,3082,3090,3090,3090,3090
.short 3090,3090,3090,3090,3090,3098,3098,3098,3098,3098,3098,3098,3106,3106,3106,3106
.short 3106,3106,3106,3106,3106,3114,3114,3114,3114,3114,3114,3114,3122,3122,3122,3122
.short 3122,3122,3122,3122,3122,3130,3130,3130,3130,3130,3130,3130,3138,3138,3138,3138
.short 3138,3138,3138,3138,3138,3146,3146,3146,3146,3146,3146,3146,3154,3154,3154,3154
.short 3154,3154,3154,3154,3154,3162,3162,3162,3162,3162,3162,3162,3170,3170,3170,3170
.short 3170,3170,3170,3170,3170,3178,3178,3178,3178,3178,3178,3178,3186,3186,3186,3186
.short 3186,3186,3186,3186,3186,3194,3194,3194,3194,3194,3194,3194,3076,3076,3076,3076
.short 3076,3076,3076,3076,3076,3084,3084,3084,3084,3084,3084,3084,3092,3092,3092,3092
.short 3092,3092,3092,3092,3092,3100,3100,3100,3100,3100,3100,3100,3108,3108,3108,3108
.short 3108,3108,3108,3108,3108,3116,3116,3116,3116,3116,3116,3116,3124,3124,3124,3124
.short 3124,3124,3124,3124,3124,3132,3132,3132,3132,3132,3132,3132,3140,3140,3140,3140
.short 3140,3140,3140,3140,3140,3148,3148,3148,3148,3148,3148,3148,3156,3156,3156,3156
.short 3156,3156,3156,3156,3156,3164,3164,3164,3164,3164,3164,3164,3172,3172,3172,3172
.short 3172,3172,3172,3172,3172,3180,3180,3180,3180,3180,3180,3180,3188,3188,3188,3188
.short 3188,3188,3188,3188,3188,3196,3196,3196,3196,3196,3196,3196,3078,3078,3078,3078
.short 3078,3078,3078,3078,3078,3086,3086,3086,3086,3086,3086,3086,3094,3094,3094,3094
.short 3094,3094,3094,3094,3094,3102,3102,3102,3102,3102,3102,3102,3110,3110,3110,3110
.short 3110,3110,3110,3110,3110,3118,3118,3118,3118,3118,3118,3118,3126,3126,3126,3126
.short 3126,3126,3126,3126,3126,3134,3134,3134,3134,3134,3134,3134,3142,3142,3142,3142
.short 3142,3142,3142,3142,3142,3150,3150,3150,3150,3150,3150,3150,3158,3158,3158,3158
.short 3158,3158,3158,3158,3158,3166,3166,3166,3166,3166,3166,3166,3174,3174,3174,3174
.short 3174,3174,3174,3174,3174,3182,3182,3182,3182,3182,3182,3182,3190,3190,3190,3190
.short 3190,3190,3190,3190,3190,3198,3198,3198,3198,3198,3198,3198,3200,3200,3200,3200
.short 3200,3200,3200,3200,3200,3208,3208,3208,3208,3208,3208,3208,3216,3216,3216,3216
.short 3216,3216,3216,3216,3216,3224,3224,3224,3224,3224,3224,3224,3232,3232,3232,3232
.short 3232,3232,3232,3232,3232,3240,3240,3240,3240,3240,3240,3240,3248,3248,3248,3248
.short 3248,3248,3248,3248,3248,3256,3256,3256,3256,3256,3256,3256,3264,3264,3264,3264
.short 3264,3264,3264,3264,3264,3272,3272,3272,3272,3272,3272,3272,3280,3280,3280,3280
.short 3280,3280,3280,3280,3280,3288,3288,3288,3288,3288,3288,3288,3296,3296,3296,3296
.short 3296,3296,3296,3296,3296,3304,3304,3304,3304,3304,3304,3304,3312,3312,3312,3312
.short 3312,3312,3312,3312,3312,3320,3320,3320,3320,3320,3320,3320,3202,3202,3202,3202
.short 3202,3202,3202,3202,3202,3210,3210,3210,3210,3210,3210,3210,3218,3218,3218,3218
.short 3218,3218,3218,3218,3218,3226,3226,3226,3226,3226,3226,3226,3234,3234,3234,3234
.short 3234,3234,3234,3234,3234,3242,3242,3242,3242,3242,3242,3242,3250,3250,3250,3250
.short 3250,3250,3250,3250,3250,3258,3258,3258,3258,3258,3258,3258,3266,3266,3266,3266
.short 3266,3266,3266,3266,3266,3274,3274,3274,3274,3274,3274,3274,3282,3282,3282,3282
.short 3282,3282,3282,3282,3282,3290,3290,3290,3290,3290,3290,3290,3298,3298,3298,3298
.short 3298,3298,3298,3298,3298,3306,3306,3306,3306,3306,3306,3306,3314,3314,3314,3314
.short 3314,3314,3314,3314,3314,3322,3322,3322,3322,3322,3322,3322,3204,3204,3204,3204
.short 3204,3204,3204,3204,3204,3212,3212,3212,3212,3212,3212,3212,3220,3220,3220,3220
.short 3220,3220,3220,3220,3220,3228,3228,3228,3228,3228,3228,3228,3236,3236,3236,3236
.short 3236,3236,3236,3236,3236,3244,3244,3244,3244,3244,3244,3244,3252,3252,3252,3252
.short 3252,3252,3252,3252,3252,3260,3260,3260,3260,3260,3260,3260,3268,3268,3268,3268
.short 3268,3268,3268,3268,3268,3276,3276,3276,3276,3276,3276,3276,3284,3284,3284,3284
.short 3284,3284,3284,3284,3284,3292,3292,3292,3292,3292,3292,3292,3300,3300,3300,3300
.short 3300,3300,3300,3300,3300,3308,3308,3308,3308,3308,3308,3308,3316,3316,3316,3316
.short 3316,3316,3316,3316,3316,3324,3324,3324,3324,3324,3324,3324,3206,3206,3206,3206
.short 3206,3206,3206,3206,3206,3214,3214,3214,3214,3214,3214,3214,3222,3222,3222,3222
.short 3222,3222,3222,3222,3222,3230,3230,3230,3230,3230,3230,3230,3238,3238,3238,3238
.short 3238,3238,3238,3238,3238,3246,3246,3246,3246,3246,3246,3246,3254,3254,3254,3254
.short 3254,3254,3254,3254,3254,3262,3262,3262,3262,3262,3262,3262,3270,3270,3270,3270
.short 3270,3270,3270,3270,3270,3278,3278,3278,3278,3278,3278,3278,3286,3286,3286,3286
.short 3286,3286,3286,3286,3286,3294,3294,3294,3294,3294,3294,3294,3302,3302,3302,3302
.short 3302,3302,3302,3302,3302,3310,3310,3310,3310,3310,3310,3310,3318,3318,3318,3318
.short 3318,3318,3318,3318,3318,3326,3326,3326,3326,3326,3326,3326,3328,3328,3328,3328
L_code_end:

.section .rodata,"a"
.p2align 6
.amdhsa_kernel sequential_preLN__ssm_conv_s4d__swiglu_ffn__prompt_kernel
  .amdhsa_next_free_vgpr 256
  .amdhsa_next_free_sgpr 102
  .amdhsa_accum_offset 256
  .amdhsa_group_segment_fixed_size 0
  .amdhsa_kernarg_size 112
  .amdhsa_user_sgpr_count 2
  .amdhsa_user_sgpr_kernarg_segment_ptr 1
  .amdhsa_system_sgpr_workgroup_id_x 1
.end_amdhsa_kernel
```
